```python
import torch

def _softmax(x, axis=-1):
    return torch.softmax(x, dim=axis)
def _gelu(x):
    return torch.nn.functional.gelu(x, approximate="tanh")
def _silu(x):
    return torch.nn.functional.silu(x)
def _sigmoid(x):
    return torch.sigmoid(x)
def _layernorm(x, axis=-1, eps=1e-5):
    m = x.mean(dim=axis, keepdim=True)
    v = x.var(dim=axis, keepdim=True, unbiased=False)
    return (x - m) / torch.sqrt(v + eps)
def _scatter_add(tgt, idx, src, axis=0):
    return tgt.clone().index_add_(axis, idx, src)
def _segment_sum(src, seg, n):
    out = torch.zeros((n,) + src.shape[1:], dtype=src.dtype)
    return out.index_add_(0, seg, src)
def _pad(x, pw):
    flat = tuple(v for pair in reversed(pw) for v in pair)
    return torch.nn.functional.pad(x, flat)

kernel_name = 'recurrent_scan__mha_block_cached__mixer_channel_mlp__decode'

def setup_inputs():

    _w = (lambda a: (lambda t: t.to(torch.bfloat16) if t.is_floating_point() else t)(torch.as_tensor(a)))
    def _A_setup():
        B, Sq, D = 4, 1, 512
        H, Sk, Dh = 32, 4096, 128
        return {
            "x": _w((lambda *s: torch.randn(*s, dtype=torch.bfloat16) * 0.1)(B, Sq, D)),
            "k_cache": _w((lambda *s: torch.randn(*s, dtype=torch.bfloat16) * 0.8)(B, H, Sk, Dh)),
            "v_cache": _w((lambda *s: torch.randn(*s, dtype=torch.bfloat16) * 3.2)(B, H, Sk, Dh)),
            "wq": _w((lambda *s: torch.randn(*s, dtype=torch.bfloat16) * 0.8)(D, H * Dh) * (D ** -0.5)),
            "wo": _w((lambda *s: torch.randn(*s, dtype=torch.bfloat16) * 3.2)(H * Dh, D) * ((H * Dh) ** -0.5)),
        }
    _A_in = _A_setup()

    def _B_setup():
        B, S, D, F = 4, 1, 512, 1792
        return {
            "x": _w((lambda *s: torch.randn(*s, dtype=torch.bfloat16) * 0.1)(B, S, D)),
            "w1": _w((lambda *s: torch.randn(*s, dtype=torch.bfloat16) * 3.2)(D, F) * (D ** -0.5)),
            "b1": _w((lambda *s: torch.randn(*s, dtype=torch.bfloat16) * 3.2)(F)),
            "w2": _w((lambda *s: torch.randn(*s, dtype=torch.bfloat16) * 3.2)(F, D) * (F ** -0.5)),
            "b2": _w((lambda *s: torch.randn(*s, dtype=torch.bfloat16) * 3.2)(D)),
        }
    _B_in = _B_setup()

    return {
        "A_x": _A_in["x"],
        "A_k_cache": _A_in["k_cache"],
        "A_v_cache": _A_in["v_cache"],
        "A_wq": _A_in["wq"],
        "A_wo": _A_in["wo"],
        "B_x": _B_in["x"],
        "B_w1": _B_in["w1"],
        "B_b1": _B_in["b1"],
        "B_w2": _B_in["w2"],
        "B_b2": _B_in["b2"],
    }

def reference(A_x, A_k_cache, A_v_cache, A_wq, A_wo, B_x, B_w1, B_b1, B_w2, B_b2):
    def _A_ref(x, k_cache, v_cache, wq, wo):
        B, Sq, D = x.shape
        H, Dh = 32, 128
        q = (lambda x, *d: x.permute(*d))((x @ wq).reshape(B, Sq, H, Dh), 0, 2, 1, 3)
        scores = torch.einsum("bhqd,bhkd->bhqk", q, k_cache) * (Dh ** -0.5)
        p = _softmax(scores, axis=-1)
        o = torch.einsum("bhqk,bhkd->bhqd", p, v_cache)
        return (lambda x, *d: x.permute(*d))(o, 0, 2, 1, 3).reshape(B, Sq, H * Dh) @ wo

    def _B_ref(x, w1, b1, w2, b2):
        y = _layernorm(x, axis=-1)
        h = _gelu(torch.einsum("bsd,df->bsf", y, w1) + b1)
        return torch.einsum("bsf,fd->bsd", h, w2) + b2

    x = A_x
    xn = _layernorm(x, axis=-1)
    s = _A_ref(xn, A_k_cache, A_v_cache, A_wq, A_wo)
    g = _silu(_B_ref(xn, B_w1, B_b1, B_w2, B_b2))
    return x + s * g
```

```asm
; @launch grid=(256,1,1) block=(512,1,1) lds=153600
.amdgcn_target "amdgcn-amd-amdhsa--gfx950"
.text
.globl recurrent_scan__mha_block_cached__mixer_channel_mlp__decode_kernel
.p2align 8
.type recurrent_scan__mha_block_cached__mixer_channel_mlp__decode_kernel,@function
recurrent_scan__mha_block_cached__mixer_channel_mlp__decode_kernel:
    s_cmp_ge_u32 s2, 256
    s_cbranch_scc1 L_end
    s_load_dwordx16 s[8:23], s[0:1], 0
    s_load_dwordx8 s[24:31], s[0:1], 64
    s_load_dwordx2 s[32:33], s[0:1], 96
    v_lshrrev_b32 v2, 6, v0
    v_and_b32 v1, 63, v0
    s_and_b32 s34, s2, 7
    v_readfirstlane_b32 s3, v2
    s_lshr_b32 s35, s2, 3
    s_bfe_u32 s36, s35, 0x20001
    s_lshl_b32 s39, s34, 2
    s_add_u32 s36, s36, s39
    s_lshr_b32 s37, s35, 3
    s_and_b32 s38, s35, 1
    s_cmp_lt_u32 s3, 4
    s_cbranch_scc0 L_S
    s_lshl_b32 s57, s35, 11
    s_cmp_ge_u32 s57, L_end-recurrent_scan__mha_block_cached__mixer_channel_mlp__decode_kernel
    s_cbranch_scc1 L_H
    s_getpc_b64 s[52:53]
L_pca:
    s_andn2_b32 s52, s52, 0xff
    v_lshl_add_u32 v2, v0, 3, s57
    v_min_u32 v2, L_end-recurrent_scan__mha_block_cached__mixer_channel_mlp__decode_kernel-4, v2
    v_mov_b32 v3, s53
    v_add_co_u32 v2, vcc, s52, v2
    s_nop 1
    v_addc_co_u32 v3, vcc, 0, v3, vcc
    global_load_dwordx2 v[250:251], v[2:3], off
    s_branch L_H
L_S:
    s_setprio 3
    s_sub_u32 s56, s3, 4
    s_lshl_b32 s57, s37, 5
    s_add_u32 s57, s57, s36
    s_lshl_b32 s57, s57, 20
    s_lshl_b32 s58, s38, 16
    s_add_u32 s57, s57, s58
    s_lshl_b32 s58, s56, 10
    s_add_u32 s57, s57, s58
    s_bfe_u32 s58, s2, 0x10005
    s_lshl_b32 s58, s58, 13
    s_xor_b32 s57, s57, s58
    s_bfe_u32 s58, s2, 0x10006
    s_lshl_b32 s58, s58, 13
    s_xor_b32 s57, s57, s58
    s_mov_b32 s59, s57
    v_lshlrev_b32 v2, 4, v1
    s_waitcnt lgkmcnt(0)
    s_mov_b32 s40, s10
    s_mov_b32 s41, s11
    s_mov_b32 s42, 0x8000000
    s_mov_b32 s43, 0x20000
    buffer_load_dwordx4 v[64:67], v2, s[40:43], s59 offen nt
    s_xor_b32 s59, s57, 0x2000
    buffer_load_dwordx4 v[68:71], v2, s[40:43], s59 offen nt
    s_xor_b32 s59, s57, 0x1000
    buffer_load_dwordx4 v[72:75], v2, s[40:43], s59 offen nt
    s_xor_b32 s59, s57, 0x3000
    buffer_load_dwordx4 v[76:79], v2, s[40:43], s59 offen nt
    s_xor_b32 s59, s57, 0x4000
    buffer_load_dwordx4 v[80:83], v2, s[40:43], s59 offen nt
    s_xor_b32 s59, s57, 0x6000
    buffer_load_dwordx4 v[84:87], v2, s[40:43], s59 offen nt
    s_xor_b32 s59, s57, 0x5000
    buffer_load_dwordx4 v[88:91], v2, s[40:43], s59 offen nt
    s_xor_b32 s59, s57, 0x7000
    s_barrier
    s_mov_b32 s48, s12
    s_mov_b32 s49, s13
    s_mov_b32 s50, 0x8000000
    s_mov_b32 s51, 0x20000
    v_and_b32 v52, 1, v1
    v_lshlrev_b32 v52, 4, v52
    s_mov_b32 s39, 0xffff
    v_lshlrev_b32_e64 v52, v52, s39
    v_bfe_u32 v53, v1, 1, 2
    v_cmp_eq_u32 vcc, 0, v53
    s_nop 1
    v_cndmask_b32 v28, 0, v52, vcc
    v_cmp_eq_u32 vcc, 1, v53
    s_nop 1
    v_cndmask_b32 v29, 0, v52, vcc
    v_cmp_eq_u32 vcc, 2, v53
    s_nop 1
    v_cndmask_b32 v30, 0, v52, vcc
    v_cmp_eq_u32 vcc, 3, v53
    s_nop 1
    v_cndmask_b32 v31, 0, v52, vcc
    s_mov_b32 s60, 0xaaaaaaaa
    s_mov_b32 s61, 0xaaaaaaaa
    s_mov_b32 s62, 0xcccccccc
    s_mov_b32 s63, 0xcccccccc
    s_mov_b32 s65, 0x3db504f3
    s_mov_b32 s66, 0x3fb8aa3b
    v_and_b32 v3, 15, v1
    v_lshlrev_b32 v3, 4, v3
    s_lshl_b32 s39, s56, 2
    v_mov_b32 v7, s39
    s_mov_b32 s72, 131072
    s_waitcnt vmcnt(6)
    buffer_load_dwordx4 v[92:95], v2, s[40:43], s59 offen nt
    s_xor_b32 s59, s57, 0x8000
    v_mov_b32 v6, 7
    ds_write_b32 v7, v6 offset:272
    s_waitcnt vmcnt(6)
    buffer_load_dwordx4 v[96:99], v2, s[40:43], s59 offen nt
    s_xor_b32 s59, s57, 0xa000
    s_waitcnt vmcnt(6)
    buffer_load_dwordx4 v[100:103], v2, s[40:43], s59 offen nt
    s_xor_b32 s59, s57, 0x9000
    v_mov_b32 v6, 9
    ds_write_b32 v7, v6 offset:272
    s_waitcnt vmcnt(4)
    buffer_load_dwordx4 v[104:107], v2, s[40:43], s59 offen nt
    s_xor_b32 s59, s57, 0xb000
    s_waitcnt vmcnt(4)
    buffer_load_dwordx4 v[108:111], v2, s[40:43], s59 offen nt
    s_xor_b32 s59, s57, 0xc000
    v_mov_b32 v6, 11
    ds_write_b32 v7, v6 offset:272
    s_waitcnt vmcnt(4)
    buffer_load_dwordx4 v[112:115], v2, s[40:43], s59 offen nt
    s_xor_b32 s59, s57, 0xe000
    s_waitcnt vmcnt(4)
    buffer_load_dwordx4 v[116:119], v2, s[40:43], s59 offen nt
    s_xor_b32 s59, s57, 0xd000
    v_mov_b32 v6, 13
    ds_write_b32 v7, v6 offset:272
    s_waitcnt vmcnt(4)
    buffer_load_dwordx4 v[120:123], v2, s[40:43], s59 offen nt
    s_xor_b32 s59, s57, 0xf000
    s_waitcnt vmcnt(4)
    buffer_load_dwordx4 v[124:127], v2, s[40:43], s59 offen nt
    s_xor_b32 s59, s57, 0x40000
    s_waitcnt vmcnt(4)
    buffer_load_dwordx4 v[128:131], v2, s[40:43], s59 offen nt
    s_xor_b32 s59, s57, 0x42000
    s_waitcnt vmcnt(4)
    buffer_load_dwordx4 v[132:135], v2, s[40:43], s59 offen nt
    s_xor_b32 s59, s57, 0x41000
    s_waitcnt vmcnt(4)
    buffer_load_dwordx4 v[136:139], v2, s[40:43], s59 offen nt
    s_xor_b32 s59, s57, 0x43000
    s_waitcnt vmcnt(4)
    buffer_load_dwordx4 v[140:143], v2, s[40:43], s59 offen nt
    s_xor_b32 s59, s57, 0x44000
    s_waitcnt vmcnt(4)
    buffer_load_dwordx4 v[144:147], v2, s[40:43], s59 offen nt
    s_xor_b32 s59, s57, 0x46000
    s_waitcnt vmcnt(4)
    buffer_load_dwordx4 v[148:151], v2, s[40:43], s59 offen nt
    s_xor_b32 s59, s57, 0x45000
    s_waitcnt vmcnt(4)
    buffer_load_dwordx4 v[152:155], v2, s[40:43], s59 offen nt
    s_xor_b32 s59, s57, 0x47000
    s_waitcnt vmcnt(4)
    buffer_load_dwordx4 v[156:159], v2, s[40:43], s59 offen nt
    s_xor_b32 s59, s57, 0x48000
    s_waitcnt vmcnt(4)
    buffer_load_dwordx4 v[160:163], v2, s[40:43], s59 offen nt
    s_xor_b32 s59, s57, 0x4a000
    s_waitcnt vmcnt(4)
    buffer_load_dwordx4 v[164:167], v2, s[40:43], s59 offen nt
    s_xor_b32 s59, s57, 0x49000
    s_waitcnt vmcnt(4)
    buffer_load_dwordx4 v[168:171], v2, s[40:43], s59 offen nt
    s_xor_b32 s59, s57, 0x4b000
    s_waitcnt vmcnt(4)
    buffer_load_dwordx4 v[172:175], v2, s[40:43], s59 offen nt
    s_xor_b32 s59, s57, 0x4c000
    s_waitcnt vmcnt(4)
    buffer_load_dwordx4 v[176:179], v2, s[40:43], s59 offen nt
    s_xor_b32 s59, s57, 0x4e000
    v_mov_b32 v6, 28
    ds_write_b32 v7, v6 offset:272
    s_waitcnt vmcnt(4)
    buffer_load_dwordx4 v[180:183], v2, s[40:43], s59 offen nt
    s_xor_b32 s59, s57, 0x4d000
    s_waitcnt vmcnt(4)
    buffer_load_dwordx4 v[184:187], v2, s[40:43], s59 offen nt
    s_xor_b32 s59, s57, 0x4f000
    s_waitcnt vmcnt(4)
    buffer_load_dwordx4 v[188:191], v2, s[40:43], s59 offen nt
    s_xor_b32 s59, s57, 0x20000
    s_waitcnt vmcnt(4)
    buffer_load_dwordx4 v[192:195], v2, s[40:43], s59 offen nt
    s_xor_b32 s59, s57, 0x22000
    s_waitcnt vmcnt(4)
    buffer_load_dwordx4 v[196:199], v2, s[40:43], s59 offen nt
    s_xor_b32 s59, s57, 0x21000
    s_waitcnt vmcnt(4)
    buffer_load_dwordx4 v[200:203], v2, s[40:43], s59 offen nt
    s_xor_b32 s59, s57, 0x23000
    s_waitcnt vmcnt(4)
    buffer_load_dwordx4 v[204:207], v2, s[40:43], s59 offen nt
    s_xor_b32 s59, s57, 0x24000
    s_waitcnt vmcnt(4)
    buffer_load_dwordx4 v[208:211], v2, s[40:43], s59 offen nt
    s_xor_b32 s59, s57, 0x26000
    s_waitcnt vmcnt(4)
    buffer_load_dwordx4 v[212:215], v2, s[40:43], s59 offen nt
    s_xor_b32 s59, s57, 0x25000
    s_waitcnt vmcnt(4)
    buffer_load_dwordx4 v[216:219], v2, s[40:43], s59 offen nt
    s_xor_b32 s59, s57, 0x27000
    s_waitcnt vmcnt(4)
    buffer_load_dwordx4 v[220:223], v2, s[40:43], s59 offen nt
    s_xor_b32 s59, s57, 0x28000
    s_waitcnt vmcnt(4)
    buffer_load_dwordx4 v[224:227], v2, s[40:43], s59 offen nt
    s_xor_b32 s59, s57, 0x2a000
    v_mov_b32 v6, 40
    ds_write_b32 v7, v6 offset:272
    s_waitcnt vmcnt(4)
    buffer_load_dwordx4 v[228:231], v2, s[40:43], s59 offen nt
    s_xor_b32 s59, s57, 0x29000
    s_waitcnt vmcnt(4)
    buffer_load_dwordx4 v[232:235], v2, s[40:43], s59 offen nt
    s_xor_b32 s59, s57, 0x2b000
    s_waitcnt vmcnt(4)
    buffer_load_dwordx4 v[236:239], v2, s[40:43], s59 offen nt
    s_xor_b32 s59, s57, 0x2c000
    s_waitcnt vmcnt(4)
    buffer_load_dwordx4 v[240:243], v2, s[40:43], s59 offen nt
    s_xor_b32 s59, s57, 0x2e000
    s_waitcnt vmcnt(4)
    buffer_load_dwordx4 v[244:247], v2, s[40:43], s59 offen nt
    s_xor_b32 s59, s57, 0x2d000
    s_waitcnt vmcnt(4)
    buffer_load_dwordx4 v[248:251], v2, s[40:43], s59 offen nt
    s_xor_b32 s59, s57, 0x2f000
    s_waitcnt vmcnt(4)
    buffer_load_dwordx4 v[252:255], v2, s[40:43], s59 offen nt
    s_xor_b32 s59, s57, 0x60000
L_QW:
    ds_read_b128 v[24:27], v3 offset:0
    s_waitcnt lgkmcnt(0)
    v_max3_u32 v52, v24, v25, v26
    v_max_u32 v52, v52, v27
    v_cmp_eq_u32 vcc, -1, v52
    s_nop 0
    s_cbranch_vccz L_QD
    s_sleep 1
    s_sub_u32 s72, s72, 1
    s_cbranch_scc0 L_QW
L_QD:
    v_mov_b32 v5, 0
    ds_read_b32 v5, v5 offset:264
    v_dot2_f32_bf16 v8, v64, v24, 0
    v_dot2_f32_bf16 v8, v65, v25, v8
    v_dot2_f32_bf16 v8, v66, v26, v8
    v_dot2_f32_bf16 v8, v67, v27, v8
    s_waitcnt vmcnt(4)
    buffer_load_dwordx4 v[64:67], v2, s[40:43], s59 offen nt
    s_xor_b32 s59, s57, 0x62000
    v_dot2_f32_bf16 v9, v68, v24, 0
    v_dot2_f32_bf16 v9, v69, v25, v9
    v_dot2_f32_bf16 v9, v70, v26, v9
    v_dot2_f32_bf16 v9, v71, v27, v9
    v_add_f32_dpp v8, v8, v8 row_ror:8 row_mask:0xf bank_mask:0x3
    s_waitcnt vmcnt(4)
    buffer_load_dwordx4 v[68:71], v2, s[40:43], s59 offen nt
    s_xor_b32 s59, s57, 0x61000
    v_dot2_f32_bf16 v10, v72, v24, 0
    v_dot2_f32_bf16 v10, v73, v25, v10
    v_dot2_f32_bf16 v10, v74, v26, v10
    v_dot2_f32_bf16 v10, v75, v27, v10
    v_add_f32_dpp v9, v9, v9 row_ror:8 row_mask:0xf bank_mask:0x3
    s_waitcnt vmcnt(4)
    buffer_load_dwordx4 v[72:75], v2, s[40:43], s59 offen nt
    s_xor_b32 s59, s57, 0x63000
    v_dot2_f32_bf16 v11, v76, v24, 0
    v_dot2_f32_bf16 v11, v77, v25, v11
    v_dot2_f32_bf16 v11, v78, v26, v11
    v_dot2_f32_bf16 v11, v79, v27, v11
    v_add_f32_dpp v10, v10, v10 row_ror:8 row_mask:0xf bank_mask:0x3
    s_waitcnt vmcnt(4)
    buffer_load_dwordx4 v[76:79], v2, s[40:43], s59 offen nt
    s_xor_b32 s59, s57, 0x64000
    v_dot2_f32_bf16 v12, v80, v24, 0
    v_dot2_f32_bf16 v12, v81, v25, v12
    v_dot2_f32_bf16 v12, v82, v26, v12
    v_dot2_f32_bf16 v12, v83, v27, v12
    v_add_f32_dpp v11, v11, v11 row_ror:8 row_mask:0xf bank_mask:0x3
    s_waitcnt vmcnt(4)
    buffer_load_dwordx4 v[80:83], v2, s[40:43], s59 offen nt
    s_xor_b32 s59, s57, 0x66000
    v_dot2_f32_bf16 v13, v84, v24, 0
    v_dot2_f32_bf16 v13, v85, v25, v13
    v_dot2_f32_bf16 v13, v86, v26, v13
    v_dot2_f32_bf16 v13, v87, v27, v13
    v_add_f32_dpp v12, v12, v12 row_ror:8 row_mask:0xf bank_mask:0x3
    s_waitcnt vmcnt(4)
    buffer_load_dwordx4 v[84:87], v2, s[40:43], s59 offen nt
    s_xor_b32 s59, s57, 0x65000
    v_dot2_f32_bf16 v14, v88, v24, 0
    v_dot2_f32_bf16 v14, v89, v25, v14
    v_dot2_f32_bf16 v14, v90, v26, v14
    v_dot2_f32_bf16 v14, v91, v27, v14
    v_add_f32_dpp v13, v13, v13 row_ror:8 row_mask:0xf bank_mask:0x3
    v_dot2_f32_bf16 v15, v92, v24, 0
    v_dot2_f32_bf16 v15, v93, v25, v15
    v_dot2_f32_bf16 v15, v94, v26, v15
    v_dot2_f32_bf16 v15, v95, v27, v15
    v_add_f32_dpp v14, v14, v14 row_ror:8 row_mask:0xf bank_mask:0x3
    s_waitcnt vmcnt(4)
    buffer_load_dwordx4 v[88:91], v2, s[40:43], s59 offen nt
    s_xor_b32 s59, s57, 0x67000
    v_dot2_f32_bf16 v16, v96, v24, 0
    v_dot2_f32_bf16 v16, v97, v25, v16
    v_dot2_f32_bf16 v16, v98, v26, v16
    v_dot2_f32_bf16 v16, v99, v27, v16
    v_add_f32_dpp v15, v15, v15 row_ror:8 row_mask:0xf bank_mask:0x3
    v_dot2_f32_bf16 v17, v100, v24, 0
    v_dot2_f32_bf16 v17, v101, v25, v17
    v_dot2_f32_bf16 v17, v102, v26, v17
    v_dot2_f32_bf16 v17, v103, v27, v17
    v_add_f32_dpp v8, v16, v16 row_ror:8 row_mask:0xf bank_mask:0xc
    s_waitcnt vmcnt(4)
    buffer_load_dwordx4 v[92:95], v2, s[40:43], s59 offen nt
    s_xor_b32 s59, s57, 0x68000
    v_dot2_f32_bf16 v18, v104, v24, 0
    v_dot2_f32_bf16 v18, v105, v25, v18
    v_dot2_f32_bf16 v18, v106, v26, v18
    v_dot2_f32_bf16 v18, v107, v27, v18
    v_add_f32_dpp v9, v17, v17 row_ror:8 row_mask:0xf bank_mask:0xc
    v_dot2_f32_bf16 v19, v108, v24, 0
    v_dot2_f32_bf16 v19, v109, v25, v19
    v_dot2_f32_bf16 v19, v110, v26, v19
    v_dot2_f32_bf16 v19, v111, v27, v19
    v_add_f32_dpp v10, v18, v18 row_ror:8 row_mask:0xf bank_mask:0xc
    s_waitcnt vmcnt(4)
    buffer_load_dwordx4 v[96:99], v2, s[40:43], s59 offen nt
    s_xor_b32 s59, s57, 0x6a000
    v_mov_b32 v6, 56
    ds_write_b32 v7, v6 offset:272
    v_dot2_f32_bf16 v20, v112, v24, 0
    v_dot2_f32_bf16 v20, v113, v25, v20
    v_dot2_f32_bf16 v20, v114, v26, v20
    v_dot2_f32_bf16 v20, v115, v27, v20
    v_add_f32_dpp v11, v19, v19 row_ror:8 row_mask:0xf bank_mask:0xc
    v_dot2_f32_bf16 v21, v116, v24, 0
    v_dot2_f32_bf16 v21, v117, v25, v21
    v_dot2_f32_bf16 v21, v118, v26, v21
    v_dot2_f32_bf16 v21, v119, v27, v21
    v_add_f32_dpp v12, v20, v20 row_ror:8 row_mask:0xf bank_mask:0xc
    s_waitcnt vmcnt(4)
    buffer_load_dwordx4 v[100:103], v2, s[40:43], s59 offen nt
    s_xor_b32 s59, s57, 0x69000
    v_dot2_f32_bf16 v22, v120, v24, 0
    v_dot2_f32_bf16 v22, v121, v25, v22
    v_dot2_f32_bf16 v22, v122, v26, v22
    v_dot2_f32_bf16 v22, v123, v27, v22
    v_add_f32_dpp v13, v21, v21 row_ror:8 row_mask:0xf bank_mask:0xc
    v_dot2_f32_bf16 v23, v124, v24, 0
    v_dot2_f32_bf16 v23, v125, v25, v23
    v_dot2_f32_bf16 v23, v126, v26, v23
    v_dot2_f32_bf16 v23, v127, v27, v23
    v_add_f32_dpp v14, v22, v22 row_ror:8 row_mask:0xf bank_mask:0xc
    s_waitcnt vmcnt(4)
    buffer_load_dwordx4 v[104:107], v2, s[40:43], s59 offen nt
    s_xor_b32 s59, s57, 0x6b000
    v_add_f32_dpp v15, v23, v23 row_ror:8 row_mask:0xf bank_mask:0xc
    v_add_f32_dpp v8, v8, v8 row_half_mirror row_mask:0xf bank_mask:0x5
    v_add_f32_dpp v9, v9, v9 row_half_mirror row_mask:0xf bank_mask:0x5
    v_add_f32_dpp v10, v10, v10 row_half_mirror row_mask:0xf bank_mask:0x5
    v_add_f32_dpp v11, v11, v11 row_half_mirror row_mask:0xf bank_mask:0x5
    v_add_f32_dpp v8, v12, v12 row_half_mirror row_mask:0xf bank_mask:0xa
    v_add_f32_dpp v9, v13, v13 row_half_mirror row_mask:0xf bank_mask:0xa
    v_add_f32_dpp v10, v14, v14 row_half_mirror row_mask:0xf bank_mask:0xa
    v_add_f32_dpp v11, v15, v15 row_half_mirror row_mask:0xf bank_mask:0xa
    v_add_f32_dpp v8, v8, v8 quad_perm:[2,3,0,1] row_mask:0xf bank_mask:0xf
    v_add_f32_dpp v9, v9, v9 quad_perm:[2,3,0,1] row_mask:0xf bank_mask:0xf
    v_add_f32_dpp v10, v10, v10 quad_perm:[2,3,0,1] row_mask:0xf bank_mask:0xf
    v_add_f32_dpp v11, v11, v11 quad_perm:[2,3,0,1] row_mask:0xf bank_mask:0xf
    v_cndmask_b32 v8, v8, v10, s[62:63]
    v_cndmask_b32 v9, v9, v11, s[62:63]
    s_nop 0
    v_add_f32_dpp v8, v8, v8 quad_perm:[1,0,3,2] row_mask:0xf bank_mask:0xf
    v_add_f32_dpp v9, v9, v9 quad_perm:[1,0,3,2] row_mask:0xf bank_mask:0xf
    v_cndmask_b32 v32, v8, v9, s[60:61]
    v_dot2_f32_bf16 v8, v128, v24, 0
    v_dot2_f32_bf16 v8, v129, v25, v8
    v_dot2_f32_bf16 v8, v130, v26, v8
    v_dot2_f32_bf16 v8, v131, v27, v8
    v_dot2_f32_bf16 v9, v132, v24, 0
    v_dot2_f32_bf16 v9, v133, v25, v9
    v_dot2_f32_bf16 v9, v134, v26, v9
    v_dot2_f32_bf16 v9, v135, v27, v9
    v_add_f32_dpp v8, v8, v8 row_ror:8 row_mask:0xf bank_mask:0x3
    s_waitcnt vmcnt(4)
    buffer_load_dwordx4 v[108:111], v2, s[40:43], s59 offen nt
    s_xor_b32 s59, s57, 0x6c000
    v_dot2_f32_bf16 v10, v136, v24, 0
    v_dot2_f32_bf16 v10, v137, v25, v10
    v_dot2_f32_bf16 v10, v138, v26, v10
    v_dot2_f32_bf16 v10, v139, v27, v10
    v_add_f32_dpp v9, v9, v9 row_ror:8 row_mask:0xf bank_mask:0x3
    v_dot2_f32_bf16 v11, v140, v24, 0
    v_dot2_f32_bf16 v11, v141, v25, v11
    v_dot2_f32_bf16 v11, v142, v26, v11
    v_dot2_f32_bf16 v11, v143, v27, v11
    v_add_f32_dpp v10, v10, v10 row_ror:8 row_mask:0xf bank_mask:0x3
    s_waitcnt vmcnt(4)
    buffer_load_dwordx4 v[112:115], v2, s[40:43], s59 offen nt
    s_xor_b32 s59, s57, 0x6e000
    v_dot2_f32_bf16 v12, v144, v24, 0
    v_dot2_f32_bf16 v12, v145, v25, v12
    v_dot2_f32_bf16 v12, v146, v26, v12
    v_dot2_f32_bf16 v12, v147, v27, v12
    v_add_f32_dpp v11, v11, v11 row_ror:8 row_mask:0xf bank_mask:0x3
    v_dot2_f32_bf16 v13, v148, v24, 0
    v_dot2_f32_bf16 v13, v149, v25, v13
    v_dot2_f32_bf16 v13, v150, v26, v13
    v_dot2_f32_bf16 v13, v151, v27, v13
    v_add_f32_dpp v12, v12, v12 row_ror:8 row_mask:0xf bank_mask:0x3
    s_waitcnt vmcnt(4)
    buffer_load_dwordx4 v[116:119], v2, s[40:43], s59 offen nt
    s_xor_b32 s59, s57, 0x6d000
    v_dot2_f32_bf16 v14, v152, v24, 0
    v_dot2_f32_bf16 v14, v153, v25, v14
    v_dot2_f32_bf16 v14, v154, v26, v14
    v_dot2_f32_bf16 v14, v155, v27, v14
    v_add_f32_dpp v13, v13, v13 row_ror:8 row_mask:0xf bank_mask:0x3
    v_dot2_f32_bf16 v15, v156, v24, 0
    v_dot2_f32_bf16 v15, v157, v25, v15
    v_dot2_f32_bf16 v15, v158, v26, v15
    v_dot2_f32_bf16 v15, v159, v27, v15
    v_add_f32_dpp v14, v14, v14 row_ror:8 row_mask:0xf bank_mask:0x3
    s_waitcnt vmcnt(4)
    buffer_load_dwordx4 v[120:123], v2, s[40:43], s59 offen nt
    s_xor_b32 s59, s57, 0x6f000
    v_dot2_f32_bf16 v16, v160, v24, 0
    v_dot2_f32_bf16 v16, v161, v25, v16
    v_dot2_f32_bf16 v16, v162, v26, v16
    v_dot2_f32_bf16 v16, v163, v27, v16
    v_add_f32_dpp v15, v15, v15 row_ror:8 row_mask:0xf bank_mask:0x3
    v_dot2_f32_bf16 v17, v164, v24, 0
    v_dot2_f32_bf16 v17, v165, v25, v17
    v_dot2_f32_bf16 v17, v166, v26, v17
    v_dot2_f32_bf16 v17, v167, v27, v17
    v_add_f32_dpp v8, v16, v16 row_ror:8 row_mask:0xf bank_mask:0xc
    s_waitcnt vmcnt(4)
    buffer_load_dwordx4 v[124:127], v2, s[40:43], s59 offen nt
    s_xor_b32 s59, s57, 0x80000
    v_dot2_f32_bf16 v18, v168, v24, 0
    v_dot2_f32_bf16 v18, v169, v25, v18
    v_dot2_f32_bf16 v18, v170, v26, v18
    v_dot2_f32_bf16 v18, v171, v27, v18
    v_add_f32_dpp v9, v17, v17 row_ror:8 row_mask:0xf bank_mask:0xc
    v_dot2_f32_bf16 v19, v172, v24, 0
    v_dot2_f32_bf16 v19, v173, v25, v19
    v_dot2_f32_bf16 v19, v174, v26, v19
    v_dot2_f32_bf16 v19, v175, v27, v19
    v_add_f32_dpp v10, v18, v18 row_ror:8 row_mask:0xf bank_mask:0xc
    s_waitcnt vmcnt(4)
    buffer_load_dwordx4 v[128:131], v2, s[40:43], s59 offen nt
    s_xor_b32 s59, s57, 0x82000
    v_mov_b32 v6, 64
    ds_write_b32 v7, v6 offset:272
    v_dot2_f32_bf16 v20, v176, v24, 0
    v_dot2_f32_bf16 v20, v177, v25, v20
    v_dot2_f32_bf16 v20, v178, v26, v20
    v_dot2_f32_bf16 v20, v179, v27, v20
    v_add_f32_dpp v11, v19, v19 row_ror:8 row_mask:0xf bank_mask:0xc
    v_dot2_f32_bf16 v21, v180, v24, 0
    v_dot2_f32_bf16 v21, v181, v25, v21
    v_dot2_f32_bf16 v21, v182, v26, v21
    v_dot2_f32_bf16 v21, v183, v27, v21
    v_add_f32_dpp v12, v20, v20 row_ror:8 row_mask:0xf bank_mask:0xc
    s_waitcnt vmcnt(4)
    buffer_load_dwordx4 v[132:135], v2, s[40:43], s59 offen nt
    s_xor_b32 s59, s57, 0x81000
    v_mov_b32 v6, 65
    ds_write_b32 v7, v6 offset:272
    v_dot2_f32_bf16 v22, v184, v24, 0
    v_dot2_f32_bf16 v22, v185, v25, v22
    v_dot2_f32_bf16 v22, v186, v26, v22
    v_dot2_f32_bf16 v22, v187, v27, v22
    v_add_f32_dpp v13, v21, v21 row_ror:8 row_mask:0xf bank_mask:0xc
    v_dot2_f32_bf16 v23, v188, v24, 0
    v_dot2_f32_bf16 v23, v189, v25, v23
    v_dot2_f32_bf16 v23, v190, v26, v23
    v_dot2_f32_bf16 v23, v191, v27, v23
    v_add_f32_dpp v14, v22, v22 row_ror:8 row_mask:0xf bank_mask:0xc
    s_waitcnt vmcnt(4)
    buffer_load_dwordx4 v[136:139], v2, s[40:43], s59 offen nt
    s_xor_b32 s59, s57, 0x83000
    v_mov_b32 v6, 66
    ds_write_b32 v7, v6 offset:272
    v_add_f32_dpp v15, v23, v23 row_ror:8 row_mask:0xf bank_mask:0xc
    v_add_f32_dpp v8, v8, v8 row_half_mirror row_mask:0xf bank_mask:0x5
    v_add_f32_dpp v9, v9, v9 row_half_mirror row_mask:0xf bank_mask:0x5
    v_add_f32_dpp v10, v10, v10 row_half_mirror row_mask:0xf bank_mask:0x5
    v_add_f32_dpp v11, v11, v11 row_half_mirror row_mask:0xf bank_mask:0x5
    v_add_f32_dpp v8, v12, v12 row_half_mirror row_mask:0xf bank_mask:0xa
    v_add_f32_dpp v9, v13, v13 row_half_mirror row_mask:0xf bank_mask:0xa
    v_add_f32_dpp v10, v14, v14 row_half_mirror row_mask:0xf bank_mask:0xa
    v_add_f32_dpp v11, v15, v15 row_half_mirror row_mask:0xf bank_mask:0xa
    v_add_f32_dpp v8, v8, v8 quad_perm:[2,3,0,1] row_mask:0xf bank_mask:0xf
    v_add_f32_dpp v9, v9, v9 quad_perm:[2,3,0,1] row_mask:0xf bank_mask:0xf
    v_add_f32_dpp v10, v10, v10 quad_perm:[2,3,0,1] row_mask:0xf bank_mask:0xf
    v_add_f32_dpp v11, v11, v11 quad_perm:[2,3,0,1] row_mask:0xf bank_mask:0xf
    v_cndmask_b32 v8, v8, v10, s[62:63]
    v_cndmask_b32 v9, v9, v11, s[62:63]
    s_nop 0
    v_add_f32_dpp v8, v8, v8 quad_perm:[1,0,3,2] row_mask:0xf bank_mask:0xf
    v_add_f32_dpp v9, v9, v9 quad_perm:[1,0,3,2] row_mask:0xf bank_mask:0xf
    v_cndmask_b32 v33, v8, v9, s[60:61]
    v_dot2_f32_bf16 v8, v192, v24, 0
    v_dot2_f32_bf16 v8, v193, v25, v8
    v_dot2_f32_bf16 v8, v194, v26, v8
    v_dot2_f32_bf16 v8, v195, v27, v8
    v_dot2_f32_bf16 v9, v196, v24, 0
    v_dot2_f32_bf16 v9, v197, v25, v9
    v_dot2_f32_bf16 v9, v198, v26, v9
    v_dot2_f32_bf16 v9, v199, v27, v9
    v_add_f32_dpp v8, v8, v8 row_ror:8 row_mask:0xf bank_mask:0x3
    s_waitcnt vmcnt(4)
    buffer_load_dwordx4 v[140:143], v2, s[40:43], s59 offen nt
    s_xor_b32 s59, s57, 0x84000
    ds_read_b32 v62, v7 offset:288
    v_mov_b32 v6, 67
    ds_write_b32 v7, v6 offset:272
    v_dot2_f32_bf16 v10, v200, v24, 0
    v_dot2_f32_bf16 v10, v201, v25, v10
    v_dot2_f32_bf16 v10, v202, v26, v10
    v_dot2_f32_bf16 v10, v203, v27, v10
    v_add_f32_dpp v9, v9, v9 row_ror:8 row_mask:0xf bank_mask:0x3
    v_dot2_f32_bf16 v11, v204, v24, 0
    v_dot2_f32_bf16 v11, v205, v25, v11
    v_dot2_f32_bf16 v11, v206, v26, v11
    v_dot2_f32_bf16 v11, v207, v27, v11
    v_add_f32_dpp v10, v10, v10 row_ror:8 row_mask:0xf bank_mask:0x3
    s_waitcnt lgkmcnt(0)
    v_readfirstlane_b32 s64, v62
    s_cmp_gt_u32 s64, 68
    s_nop 2
    s_cbranch_scc1 L_wk68
    s_waitcnt vmcnt(4)
L_wk68:
    buffer_load_dwordx4 v[144:147], v2, s[40:43], s59 offen nt
    s_xor_b32 s59, s57, 0x86000
    v_mov_b32 v6, 68
    ds_write_b32 v7, v6 offset:272
    v_dot2_f32_bf16 v12, v208, v24, 0
    v_dot2_f32_bf16 v12, v209, v25, v12
    v_dot2_f32_bf16 v12, v210, v26, v12
    v_dot2_f32_bf16 v12, v211, v27, v12
    v_add_f32_dpp v11, v11, v11 row_ror:8 row_mask:0xf bank_mask:0x3
    v_dot2_f32_bf16 v13, v212, v24, 0
    v_dot2_f32_bf16 v13, v213, v25, v13
    v_dot2_f32_bf16 v13, v214, v26, v13
    v_dot2_f32_bf16 v13, v215, v27, v13
    v_add_f32_dpp v12, v12, v12 row_ror:8 row_mask:0xf bank_mask:0x3
    s_cmp_gt_u32 s64, 69
    s_cbranch_scc1 L_wk69
    s_waitcnt vmcnt(4)
L_wk69:
    buffer_load_dwordx4 v[148:151], v2, s[40:43], s59 offen nt
    s_xor_b32 s59, s57, 0x85000
    ds_read_b32 v62, v7 offset:288
    v_mov_b32 v6, 69
    ds_write_b32 v7, v6 offset:272
    v_dot2_f32_bf16 v14, v216, v24, 0
    v_dot2_f32_bf16 v14, v217, v25, v14
    v_dot2_f32_bf16 v14, v218, v26, v14
    v_dot2_f32_bf16 v14, v219, v27, v14
    v_add_f32_dpp v13, v13, v13 row_ror:8 row_mask:0xf bank_mask:0x3
    v_dot2_f32_bf16 v15, v220, v24, 0
    v_dot2_f32_bf16 v15, v221, v25, v15
    v_dot2_f32_bf16 v15, v222, v26, v15
    v_dot2_f32_bf16 v15, v223, v27, v15
    v_add_f32_dpp v14, v14, v14 row_ror:8 row_mask:0xf bank_mask:0x3
    s_waitcnt lgkmcnt(0)
    v_readfirstlane_b32 s64, v62
    s_cmp_gt_u32 s64, 70
    s_nop 2
    s_cbranch_scc1 L_wk70
    s_waitcnt vmcnt(4)
L_wk70:
    s_waitcnt vmcnt(6)
    buffer_load_dwordx4 v[152:155], v2, s[40:43], s59 offen nt
    s_xor_b32 s59, s57, 0x87000
    v_mov_b32 v6, 70
    ds_write_b32 v7, v6 offset:272
    v_dot2_f32_bf16 v16, v224, v24, 0
    v_dot2_f32_bf16 v16, v225, v25, v16
    v_dot2_f32_bf16 v16, v226, v26, v16
    v_dot2_f32_bf16 v16, v227, v27, v16
    v_add_f32_dpp v15, v15, v15 row_ror:8 row_mask:0xf bank_mask:0x3
    v_dot2_f32_bf16 v17, v228, v24, 0
    v_dot2_f32_bf16 v17, v229, v25, v17
    v_dot2_f32_bf16 v17, v230, v26, v17
    v_dot2_f32_bf16 v17, v231, v27, v17
    v_add_f32_dpp v8, v16, v16 row_ror:8 row_mask:0xf bank_mask:0xc
    s_cmp_gt_u32 s64, 71
    s_cbranch_scc1 L_wk71
    s_waitcnt vmcnt(4)
L_wk71:
    s_waitcnt vmcnt(6)
    buffer_load_dwordx4 v[156:159], v2, s[40:43], s59 offen nt
    s_xor_b32 s59, s57, 0x88000
    ds_read_b32 v62, v7 offset:288
    v_mov_b32 v6, 71
    ds_write_b32 v7, v6 offset:272
    v_dot2_f32_bf16 v18, v232, v24, 0
    v_dot2_f32_bf16 v18, v233, v25, v18
    v_dot2_f32_bf16 v18, v234, v26, v18
    v_dot2_f32_bf16 v18, v235, v27, v18
    v_add_f32_dpp v9, v17, v17 row_ror:8 row_mask:0xf bank_mask:0xc
    v_dot2_f32_bf16 v19, v236, v24, 0
    v_dot2_f32_bf16 v19, v237, v25, v19
    v_dot2_f32_bf16 v19, v238, v26, v19
    v_dot2_f32_bf16 v19, v239, v27, v19
    v_add_f32_dpp v10, v18, v18 row_ror:8 row_mask:0xf bank_mask:0xc
    s_waitcnt lgkmcnt(0)
    v_readfirstlane_b32 s64, v62
    s_cmp_gt_u32 s64, 72
    s_nop 2
    s_cbranch_scc1 L_wk72
    s_waitcnt vmcnt(4)
L_wk72:
    s_waitcnt vmcnt(6)
    buffer_load_dwordx4 v[160:163], v2, s[40:43], s59 offen nt
    s_xor_b32 s59, s57, 0x8a000
    v_mov_b32 v6, 72
    ds_write_b32 v7, v6 offset:272
    v_dot2_f32_bf16 v20, v240, v24, 0
    v_dot2_f32_bf16 v20, v241, v25, v20
    v_dot2_f32_bf16 v20, v242, v26, v20
    v_dot2_f32_bf16 v20, v243, v27, v20
    v_add_f32_dpp v11, v19, v19 row_ror:8 row_mask:0xf bank_mask:0xc
    v_dot2_f32_bf16 v21, v244, v24, 0
    v_dot2_f32_bf16 v21, v245, v25, v21
    v_dot2_f32_bf16 v21, v246, v26, v21
    v_dot2_f32_bf16 v21, v247, v27, v21
    v_add_f32_dpp v12, v20, v20 row_ror:8 row_mask:0xf bank_mask:0xc
    s_cmp_gt_u32 s64, 73
    s_cbranch_scc1 L_wk73
    s_waitcnt vmcnt(4)
L_wk73:
    s_waitcnt vmcnt(6)
    buffer_load_dwordx4 v[164:167], v2, s[40:43], s59 offen nt
    s_xor_b32 s59, s57, 0x89000
    ds_read_b32 v62, v7 offset:288
    v_mov_b32 v6, 73
    ds_write_b32 v7, v6 offset:272
    v_dot2_f32_bf16 v22, v248, v24, 0
    v_dot2_f32_bf16 v22, v249, v25, v22
    v_dot2_f32_bf16 v22, v250, v26, v22
    v_dot2_f32_bf16 v22, v251, v27, v22
    v_add_f32_dpp v13, v21, v21 row_ror:8 row_mask:0xf bank_mask:0xc
    v_dot2_f32_bf16 v23, v252, v24, 0
    v_dot2_f32_bf16 v23, v253, v25, v23
    v_dot2_f32_bf16 v23, v254, v26, v23
    v_dot2_f32_bf16 v23, v255, v27, v23
    v_add_f32_dpp v14, v22, v22 row_ror:8 row_mask:0xf bank_mask:0xc
    s_waitcnt lgkmcnt(0)
    v_readfirstlane_b32 s64, v62
    s_cmp_gt_u32 s64, 74
    s_nop 2
    s_cbranch_scc1 L_wk74
    s_waitcnt vmcnt(4)
L_wk74:
    s_waitcnt vmcnt(6)
    buffer_load_dwordx4 v[168:171], v2, s[40:43], s59 offen nt
    s_xor_b32 s59, s57, 0x8b000
    v_mov_b32 v6, 74
    ds_write_b32 v7, v6 offset:272
    v_add_f32_dpp v15, v23, v23 row_ror:8 row_mask:0xf bank_mask:0xc
    v_add_f32_dpp v8, v8, v8 row_half_mirror row_mask:0xf bank_mask:0x5
    v_add_f32_dpp v9, v9, v9 row_half_mirror row_mask:0xf bank_mask:0x5
    v_add_f32_dpp v10, v10, v10 row_half_mirror row_mask:0xf bank_mask:0x5
    v_add_f32_dpp v11, v11, v11 row_half_mirror row_mask:0xf bank_mask:0x5
    v_add_f32_dpp v8, v12, v12 row_half_mirror row_mask:0xf bank_mask:0xa
    v_add_f32_dpp v9, v13, v13 row_half_mirror row_mask:0xf bank_mask:0xa
    v_add_f32_dpp v10, v14, v14 row_half_mirror row_mask:0xf bank_mask:0xa
    v_add_f32_dpp v11, v15, v15 row_half_mirror row_mask:0xf bank_mask:0xa
    v_add_f32_dpp v8, v8, v8 quad_perm:[2,3,0,1] row_mask:0xf bank_mask:0xf
    v_add_f32_dpp v9, v9, v9 quad_perm:[2,3,0,1] row_mask:0xf bank_mask:0xf
    v_add_f32_dpp v10, v10, v10 quad_perm:[2,3,0,1] row_mask:0xf bank_mask:0xf
    v_add_f32_dpp v11, v11, v11 quad_perm:[2,3,0,1] row_mask:0xf bank_mask:0xf
    v_cndmask_b32 v8, v8, v10, s[62:63]
    v_cndmask_b32 v9, v9, v11, s[62:63]
    s_nop 0
    v_add_f32_dpp v8, v8, v8 quad_perm:[1,0,3,2] row_mask:0xf bank_mask:0xf
    v_add_f32_dpp v9, v9, v9 quad_perm:[1,0,3,2] row_mask:0xf bank_mask:0xf
    v_cndmask_b32 v34, v8, v9, s[60:61]
    v_dot2_f32_bf16 v8, v64, v24, 0
    v_dot2_f32_bf16 v8, v65, v25, v8
    v_dot2_f32_bf16 v8, v66, v26, v8
    v_dot2_f32_bf16 v8, v67, v27, v8
    v_dot2_f32_bf16 v9, v68, v24, 0
    v_dot2_f32_bf16 v9, v69, v25, v9
    v_dot2_f32_bf16 v9, v70, v26, v9
    v_dot2_f32_bf16 v9, v71, v27, v9
    v_add_f32_dpp v8, v8, v8 row_ror:8 row_mask:0xf bank_mask:0x3
    s_cmp_gt_u32 s64, 75
    s_cbranch_scc1 L_wk75
    s_waitcnt vmcnt(4)
L_wk75:
    s_waitcnt vmcnt(6)
    buffer_load_dwordx4 v[172:175], v2, s[40:43], s59 offen nt
    s_xor_b32 s59, s57, 0x8c000
    ds_read_b32 v62, v7 offset:288
    v_mov_b32 v6, 75
    ds_write_b32 v7, v6 offset:272
    v_dot2_f32_bf16 v10, v72, v24, 0
    v_dot2_f32_bf16 v10, v73, v25, v10
    v_dot2_f32_bf16 v10, v74, v26, v10
    v_dot2_f32_bf16 v10, v75, v27, v10
    v_add_f32_dpp v9, v9, v9 row_ror:8 row_mask:0xf bank_mask:0x3
    v_dot2_f32_bf16 v11, v76, v24, 0
    v_dot2_f32_bf16 v11, v77, v25, v11
    v_dot2_f32_bf16 v11, v78, v26, v11
    v_dot2_f32_bf16 v11, v79, v27, v11
    v_add_f32_dpp v10, v10, v10 row_ror:8 row_mask:0xf bank_mask:0x3
    s_waitcnt lgkmcnt(0)
    v_readfirstlane_b32 s64, v62
    s_cmp_gt_u32 s64, 76
    s_nop 2
    s_cbranch_scc1 L_wk76
    s_waitcnt vmcnt(4)
L_wk76:
    s_waitcnt vmcnt(6)
    buffer_load_dwordx4 v[176:179], v2, s[40:43], s59 offen nt
    s_xor_b32 s59, s57, 0x8e000
    v_mov_b32 v6, 76
    ds_write_b32 v7, v6 offset:272
    v_dot2_f32_bf16 v12, v80, v24, 0
    v_dot2_f32_bf16 v12, v81, v25, v12
    v_dot2_f32_bf16 v12, v82, v26, v12
    v_dot2_f32_bf16 v12, v83, v27, v12
    v_add_f32_dpp v11, v11, v11 row_ror:8 row_mask:0xf bank_mask:0x3
    v_dot2_f32_bf16 v13, v84, v24, 0
    v_dot2_f32_bf16 v13, v85, v25, v13
    v_dot2_f32_bf16 v13, v86, v26, v13
    v_dot2_f32_bf16 v13, v87, v27, v13
    v_add_f32_dpp v12, v12, v12 row_ror:8 row_mask:0xf bank_mask:0x3
    s_cmp_gt_u32 s64, 77
    s_cbranch_scc1 L_wk77
    s_waitcnt vmcnt(4)
L_wk77:
    s_waitcnt vmcnt(6)
    buffer_load_dwordx4 v[180:183], v2, s[40:43], s59 offen nt
    s_xor_b32 s59, s57, 0x8d000
    ds_read_b32 v62, v7 offset:288
    v_mov_b32 v6, 77
    ds_write_b32 v7, v6 offset:272
    v_dot2_f32_bf16 v14, v88, v24, 0
    v_dot2_f32_bf16 v14, v89, v25, v14
    v_dot2_f32_bf16 v14, v90, v26, v14
    v_dot2_f32_bf16 v14, v91, v27, v14
    v_add_f32_dpp v13, v13, v13 row_ror:8 row_mask:0xf bank_mask:0x3
    v_dot2_f32_bf16 v15, v92, v24, 0
    v_dot2_f32_bf16 v15, v93, v25, v15
    v_dot2_f32_bf16 v15, v94, v26, v15
    v_dot2_f32_bf16 v15, v95, v27, v15
    v_add_f32_dpp v14, v14, v14 row_ror:8 row_mask:0xf bank_mask:0x3
    s_waitcnt lgkmcnt(0)
    v_readfirstlane_b32 s64, v62
    s_cmp_gt_u32 s64, 78
    s_nop 2
    s_cbranch_scc1 L_wk78
    s_waitcnt vmcnt(4)
L_wk78:
    s_waitcnt vmcnt(6)
    buffer_load_dwordx4 v[184:187], v2, s[40:43], s59 offen nt
    s_xor_b32 s59, s57, 0x8f000
    v_mov_b32 v6, 78
    ds_write_b32 v7, v6 offset:272
    v_dot2_f32_bf16 v16, v96, v24, 0
    v_dot2_f32_bf16 v16, v97, v25, v16
    v_dot2_f32_bf16 v16, v98, v26, v16
    v_dot2_f32_bf16 v16, v99, v27, v16
    v_add_f32_dpp v15, v15, v15 row_ror:8 row_mask:0xf bank_mask:0x3
    v_dot2_f32_bf16 v17, v100, v24, 0
    v_dot2_f32_bf16 v17, v101, v25, v17
    v_dot2_f32_bf16 v17, v102, v26, v17
    v_dot2_f32_bf16 v17, v103, v27, v17
    v_add_f32_dpp v8, v16, v16 row_ror:8 row_mask:0xf bank_mask:0xc
    s_cmp_gt_u32 s64, 79
    s_cbranch_scc1 L_wk79
    s_waitcnt vmcnt(4)
L_wk79:
    s_waitcnt vmcnt(6)
    buffer_load_dwordx4 v[188:191], v2, s[40:43], s59 offen nt
    s_xor_b32 s59, s57, 0xc0000
    ds_read_b32 v62, v7 offset:288
    v_mov_b32 v6, 79
    ds_write_b32 v7, v6 offset:272
    v_dot2_f32_bf16 v18, v104, v24, 0
    v_dot2_f32_bf16 v18, v105, v25, v18
    v_dot2_f32_bf16 v18, v106, v26, v18
    v_dot2_f32_bf16 v18, v107, v27, v18
    v_add_f32_dpp v9, v17, v17 row_ror:8 row_mask:0xf bank_mask:0xc
    v_dot2_f32_bf16 v19, v108, v24, 0
    v_dot2_f32_bf16 v19, v109, v25, v19
    v_dot2_f32_bf16 v19, v110, v26, v19
    v_dot2_f32_bf16 v19, v111, v27, v19
    v_add_f32_dpp v10, v18, v18 row_ror:8 row_mask:0xf bank_mask:0xc
    s_waitcnt lgkmcnt(0)
    v_readfirstlane_b32 s64, v62
    s_cmp_gt_u32 s64, 80
    s_nop 2
    s_cbranch_scc1 L_wk80
    s_waitcnt vmcnt(4)
L_wk80:
    s_waitcnt vmcnt(6)
    buffer_load_dwordx4 v[192:195], v2, s[40:43], s59 offen nt
    s_xor_b32 s59, s57, 0xc2000
    v_mov_b32 v6, 80
    ds_write_b32 v7, v6 offset:272
    v_dot2_f32_bf16 v20, v112, v24, 0
    v_dot2_f32_bf16 v20, v113, v25, v20
    v_dot2_f32_bf16 v20, v114, v26, v20
    v_dot2_f32_bf16 v20, v115, v27, v20
    v_add_f32_dpp v11, v19, v19 row_ror:8 row_mask:0xf bank_mask:0xc
    v_dot2_f32_bf16 v21, v116, v24, 0
    v_dot2_f32_bf16 v21, v117, v25, v21
    v_dot2_f32_bf16 v21, v118, v26, v21
    v_dot2_f32_bf16 v21, v119, v27, v21
    v_add_f32_dpp v12, v20, v20 row_ror:8 row_mask:0xf bank_mask:0xc
    s_cmp_gt_u32 s64, 81
    s_cbranch_scc1 L_wk81
    s_waitcnt vmcnt(4)
L_wk81:
    s_waitcnt vmcnt(6)
    buffer_load_dwordx4 v[196:199], v2, s[40:43], s59 offen nt
    s_xor_b32 s59, s57, 0xc1000
    ds_read_b32 v62, v7 offset:288
    v_mov_b32 v6, 81
    ds_write_b32 v7, v6 offset:272
    v_dot2_f32_bf16 v22, v120, v24, 0
    v_dot2_f32_bf16 v22, v121, v25, v22
    v_dot2_f32_bf16 v22, v122, v26, v22
    v_dot2_f32_bf16 v22, v123, v27, v22
    v_add_f32_dpp v13, v21, v21 row_ror:8 row_mask:0xf bank_mask:0xc
    v_dot2_f32_bf16 v23, v124, v24, 0
    v_dot2_f32_bf16 v23, v125, v25, v23
    v_dot2_f32_bf16 v23, v126, v26, v23
    v_dot2_f32_bf16 v23, v127, v27, v23
    v_add_f32_dpp v14, v22, v22 row_ror:8 row_mask:0xf bank_mask:0xc
    s_waitcnt lgkmcnt(0)
    v_readfirstlane_b32 s64, v62
    s_cmp_gt_u32 s64, 82
    s_nop 2
    s_cbranch_scc1 L_wk82
    s_waitcnt vmcnt(4)
L_wk82:
    s_waitcnt vmcnt(6)
    buffer_load_dwordx4 v[200:203], v2, s[40:43], s59 offen nt
    s_xor_b32 s59, s57, 0xc3000
    v_mov_b32 v6, 82
    ds_write_b32 v7, v6 offset:272
    v_add_f32_dpp v15, v23, v23 row_ror:8 row_mask:0xf bank_mask:0xc
    v_add_f32_dpp v8, v8, v8 row_half_mirror row_mask:0xf bank_mask:0x5
    v_add_f32_dpp v9, v9, v9 row_half_mirror row_mask:0xf bank_mask:0x5
    v_add_f32_dpp v10, v10, v10 row_half_mirror row_mask:0xf bank_mask:0x5
    v_add_f32_dpp v11, v11, v11 row_half_mirror row_mask:0xf bank_mask:0x5
    v_add_f32_dpp v8, v12, v12 row_half_mirror row_mask:0xf bank_mask:0xa
    v_add_f32_dpp v9, v13, v13 row_half_mirror row_mask:0xf bank_mask:0xa
    v_add_f32_dpp v10, v14, v14 row_half_mirror row_mask:0xf bank_mask:0xa
    v_add_f32_dpp v11, v15, v15 row_half_mirror row_mask:0xf bank_mask:0xa
    v_add_f32_dpp v8, v8, v8 quad_perm:[2,3,0,1] row_mask:0xf bank_mask:0xf
    v_add_f32_dpp v9, v9, v9 quad_perm:[2,3,0,1] row_mask:0xf bank_mask:0xf
    v_add_f32_dpp v10, v10, v10 quad_perm:[2,3,0,1] row_mask:0xf bank_mask:0xf
    v_add_f32_dpp v11, v11, v11 quad_perm:[2,3,0,1] row_mask:0xf bank_mask:0xf
    v_cndmask_b32 v8, v8, v10, s[62:63]
    v_cndmask_b32 v9, v9, v11, s[62:63]
    s_nop 0
    v_add_f32_dpp v8, v8, v8 quad_perm:[1,0,3,2] row_mask:0xf bank_mask:0xf
    v_add_f32_dpp v9, v9, v9 quad_perm:[1,0,3,2] row_mask:0xf bank_mask:0xf
    v_cndmask_b32 v35, v8, v9, s[60:61]
    v_dot2_f32_bf16 v8, v128, v24, 0
    v_dot2_f32_bf16 v8, v129, v25, v8
    v_dot2_f32_bf16 v8, v130, v26, v8
    v_dot2_f32_bf16 v8, v131, v27, v8
    v_dot2_f32_bf16 v9, v132, v24, 0
    v_dot2_f32_bf16 v9, v133, v25, v9
    v_dot2_f32_bf16 v9, v134, v26, v9
    v_dot2_f32_bf16 v9, v135, v27, v9
    v_add_f32_dpp v8, v8, v8 row_ror:8 row_mask:0xf bank_mask:0x3
    s_cmp_gt_u32 s64, 83
    s_cbranch_scc1 L_wk83
    s_waitcnt vmcnt(4)
L_wk83:
    s_waitcnt vmcnt(6)
    buffer_load_dwordx4 v[204:207], v2, s[40:43], s59 offen nt
    s_xor_b32 s59, s57, 0xc4000
    ds_read_b32 v62, v7 offset:288
    v_mov_b32 v6, 83
    ds_write_b32 v7, v6 offset:272
    v_dot2_f32_bf16 v10, v136, v24, 0
    v_dot2_f32_bf16 v10, v137, v25, v10
    v_dot2_f32_bf16 v10, v138, v26, v10
    v_dot2_f32_bf16 v10, v139, v27, v10
    v_add_f32_dpp v9, v9, v9 row_ror:8 row_mask:0xf bank_mask:0x3
    v_dot2_f32_bf16 v11, v140, v24, 0
    v_dot2_f32_bf16 v11, v141, v25, v11
    v_dot2_f32_bf16 v11, v142, v26, v11
    v_dot2_f32_bf16 v11, v143, v27, v11
    v_add_f32_dpp v10, v10, v10 row_ror:8 row_mask:0xf bank_mask:0x3
    s_waitcnt lgkmcnt(0)
    v_readfirstlane_b32 s64, v62
    s_cmp_gt_u32 s64, 84
    s_nop 2
    s_cbranch_scc1 L_wk84
    s_waitcnt vmcnt(4)
L_wk84:
    s_waitcnt vmcnt(6)
    buffer_load_dwordx4 v[208:211], v2, s[40:43], s59 offen nt
    s_xor_b32 s59, s57, 0xc6000
    v_mov_b32 v6, 84
    ds_write_b32 v7, v6 offset:272
    v_dot2_f32_bf16 v12, v144, v24, 0
    v_dot2_f32_bf16 v12, v145, v25, v12
    v_dot2_f32_bf16 v12, v146, v26, v12
    v_dot2_f32_bf16 v12, v147, v27, v12
    v_add_f32_dpp v11, v11, v11 row_ror:8 row_mask:0xf bank_mask:0x3
    v_dot2_f32_bf16 v13, v148, v24, 0
    v_dot2_f32_bf16 v13, v149, v25, v13
    v_dot2_f32_bf16 v13, v150, v26, v13
    v_dot2_f32_bf16 v13, v151, v27, v13
    v_add_f32_dpp v12, v12, v12 row_ror:8 row_mask:0xf bank_mask:0x3
    s_cmp_gt_u32 s64, 85
    s_cbranch_scc1 L_wk85
    s_waitcnt vmcnt(4)
L_wk85:
    s_waitcnt vmcnt(6)
    buffer_load_dwordx4 v[212:215], v2, s[40:43], s59 offen nt
    s_xor_b32 s59, s57, 0xc5000
    ds_read_b32 v62, v7 offset:288
    v_mov_b32 v6, 85
    ds_write_b32 v7, v6 offset:272
    v_dot2_f32_bf16 v14, v152, v24, 0
    v_dot2_f32_bf16 v14, v153, v25, v14
    v_dot2_f32_bf16 v14, v154, v26, v14
    v_dot2_f32_bf16 v14, v155, v27, v14
    v_add_f32_dpp v13, v13, v13 row_ror:8 row_mask:0xf bank_mask:0x3
    v_dot2_f32_bf16 v15, v156, v24, 0
    v_dot2_f32_bf16 v15, v157, v25, v15
    v_dot2_f32_bf16 v15, v158, v26, v15
    v_dot2_f32_bf16 v15, v159, v27, v15
    v_add_f32_dpp v14, v14, v14 row_ror:8 row_mask:0xf bank_mask:0x3
    s_waitcnt lgkmcnt(0)
    v_readfirstlane_b32 s64, v62
    s_cmp_gt_u32 s64, 86
    s_nop 2
    s_cbranch_scc1 L_wk86
    s_waitcnt vmcnt(4)
L_wk86:
    s_waitcnt vmcnt(6)
    buffer_load_dwordx4 v[216:219], v2, s[40:43], s59 offen nt
    s_xor_b32 s59, s57, 0xc7000
    v_mov_b32 v6, 86
    ds_write_b32 v7, v6 offset:272
    v_dot2_f32_bf16 v16, v160, v24, 0
    v_dot2_f32_bf16 v16, v161, v25, v16
    v_dot2_f32_bf16 v16, v162, v26, v16
    v_dot2_f32_bf16 v16, v163, v27, v16
    v_add_f32_dpp v15, v15, v15 row_ror:8 row_mask:0xf bank_mask:0x3
    v_dot2_f32_bf16 v17, v164, v24, 0
    v_dot2_f32_bf16 v17, v165, v25, v17
    v_dot2_f32_bf16 v17, v166, v26, v17
    v_dot2_f32_bf16 v17, v167, v27, v17
    v_add_f32_dpp v8, v16, v16 row_ror:8 row_mask:0xf bank_mask:0xc
    s_cmp_gt_u32 s64, 87
    s_cbranch_scc1 L_wk87
    s_waitcnt vmcnt(4)
L_wk87:
    s_waitcnt vmcnt(6)
    buffer_load_dwordx4 v[220:223], v2, s[40:43], s59 offen nt
    s_xor_b32 s59, s57, 0xc8000
    ds_read_b32 v62, v7 offset:288
    v_mov_b32 v6, 87
    ds_write_b32 v7, v6 offset:272
    v_dot2_f32_bf16 v18, v168, v24, 0
    v_dot2_f32_bf16 v18, v169, v25, v18
    v_dot2_f32_bf16 v18, v170, v26, v18
    v_dot2_f32_bf16 v18, v171, v27, v18
    v_add_f32_dpp v9, v17, v17 row_ror:8 row_mask:0xf bank_mask:0xc
    v_dot2_f32_bf16 v19, v172, v24, 0
    v_dot2_f32_bf16 v19, v173, v25, v19
    v_dot2_f32_bf16 v19, v174, v26, v19
    v_dot2_f32_bf16 v19, v175, v27, v19
    v_add_f32_dpp v10, v18, v18 row_ror:8 row_mask:0xf bank_mask:0xc
    s_waitcnt lgkmcnt(0)
    v_readfirstlane_b32 s64, v62
    s_cmp_gt_u32 s64, 88
    s_nop 2
    s_cbranch_scc1 L_wk88
    s_waitcnt vmcnt(4)
L_wk88:
    s_waitcnt vmcnt(6)
    buffer_load_dwordx4 v[224:227], v2, s[40:43], s59 offen nt
    s_xor_b32 s59, s57, 0xca000
    v_mov_b32 v6, 88
    ds_write_b32 v7, v6 offset:272
    v_dot2_f32_bf16 v20, v176, v24, 0
    v_dot2_f32_bf16 v20, v177, v25, v20
    v_dot2_f32_bf16 v20, v178, v26, v20
    v_dot2_f32_bf16 v20, v179, v27, v20
    v_add_f32_dpp v11, v19, v19 row_ror:8 row_mask:0xf bank_mask:0xc
    v_dot2_f32_bf16 v21, v180, v24, 0
    v_dot2_f32_bf16 v21, v181, v25, v21
    v_dot2_f32_bf16 v21, v182, v26, v21
    v_dot2_f32_bf16 v21, v183, v27, v21
    v_add_f32_dpp v12, v20, v20 row_ror:8 row_mask:0xf bank_mask:0xc
    s_cmp_gt_u32 s64, 89
    s_cbranch_scc1 L_wk89
    s_waitcnt vmcnt(4)
L_wk89:
    s_waitcnt vmcnt(6)
    buffer_load_dwordx4 v[228:231], v2, s[40:43], s59 offen nt
    s_xor_b32 s59, s57, 0xc9000
    ds_read_b32 v62, v7 offset:288
    v_mov_b32 v6, 89
    ds_write_b32 v7, v6 offset:272
    v_dot2_f32_bf16 v22, v184, v24, 0
    v_dot2_f32_bf16 v22, v185, v25, v22
    v_dot2_f32_bf16 v22, v186, v26, v22
    v_dot2_f32_bf16 v22, v187, v27, v22
    v_add_f32_dpp v13, v21, v21 row_ror:8 row_mask:0xf bank_mask:0xc
    v_dot2_f32_bf16 v23, v188, v24, 0
    v_dot2_f32_bf16 v23, v189, v25, v23
    v_dot2_f32_bf16 v23, v190, v26, v23
    v_dot2_f32_bf16 v23, v191, v27, v23
    v_add_f32_dpp v14, v22, v22 row_ror:8 row_mask:0xf bank_mask:0xc
    s_waitcnt lgkmcnt(0)
    v_readfirstlane_b32 s64, v62
    s_cmp_gt_u32 s64, 90
    s_nop 2
    s_cbranch_scc1 L_wk90
    s_waitcnt vmcnt(4)
L_wk90:
    s_waitcnt vmcnt(6)
    buffer_load_dwordx4 v[232:235], v2, s[40:43], s59 offen nt
    s_xor_b32 s59, s57, 0xcb000
    v_mov_b32 v6, 90
    ds_write_b32 v7, v6 offset:272
    v_add_f32_dpp v15, v23, v23 row_ror:8 row_mask:0xf bank_mask:0xc
    v_add_f32_dpp v8, v8, v8 row_half_mirror row_mask:0xf bank_mask:0x5
    v_add_f32_dpp v9, v9, v9 row_half_mirror row_mask:0xf bank_mask:0x5
    v_add_f32_dpp v10, v10, v10 row_half_mirror row_mask:0xf bank_mask:0x5
    v_add_f32_dpp v11, v11, v11 row_half_mirror row_mask:0xf bank_mask:0x5
    v_add_f32_dpp v8, v12, v12 row_half_mirror row_mask:0xf bank_mask:0xa
    v_add_f32_dpp v9, v13, v13 row_half_mirror row_mask:0xf bank_mask:0xa
    v_add_f32_dpp v10, v14, v14 row_half_mirror row_mask:0xf bank_mask:0xa
    v_add_f32_dpp v11, v15, v15 row_half_mirror row_mask:0xf bank_mask:0xa
    v_add_f32_dpp v8, v8, v8 quad_perm:[2,3,0,1] row_mask:0xf bank_mask:0xf
    v_add_f32_dpp v9, v9, v9 quad_perm:[2,3,0,1] row_mask:0xf bank_mask:0xf
    v_add_f32_dpp v10, v10, v10 quad_perm:[2,3,0,1] row_mask:0xf bank_mask:0xf
    v_add_f32_dpp v11, v11, v11 quad_perm:[2,3,0,1] row_mask:0xf bank_mask:0xf
    v_cndmask_b32 v8, v8, v10, s[62:63]
    v_cndmask_b32 v9, v9, v11, s[62:63]
    s_nop 0
    v_add_f32_dpp v8, v8, v8 quad_perm:[1,0,3,2] row_mask:0xf bank_mask:0xf
    v_add_f32_dpp v9, v9, v9 quad_perm:[1,0,3,2] row_mask:0xf bank_mask:0xf
    v_cndmask_b32 v36, v8, v9, s[60:61]
    v_dot2_f32_bf16 v8, v192, v24, 0
    v_dot2_f32_bf16 v8, v193, v25, v8
    v_dot2_f32_bf16 v8, v194, v26, v8
    v_dot2_f32_bf16 v8, v195, v27, v8
    v_dot2_f32_bf16 v9, v196, v24, 0
    v_dot2_f32_bf16 v9, v197, v25, v9
    v_dot2_f32_bf16 v9, v198, v26, v9
    v_dot2_f32_bf16 v9, v199, v27, v9
    v_add_f32_dpp v8, v8, v8 row_ror:8 row_mask:0xf bank_mask:0x3
    s_cmp_gt_u32 s64, 91
    s_cbranch_scc1 L_wk91
    s_waitcnt vmcnt(4)
L_wk91:
    s_waitcnt vmcnt(6)
    buffer_load_dwordx4 v[236:239], v2, s[40:43], s59 offen nt
    s_xor_b32 s59, s57, 0xcc000
    ds_read_b32 v62, v7 offset:288
    v_mov_b32 v6, 91
    ds_write_b32 v7, v6 offset:272
    v_dot2_f32_bf16 v10, v200, v24, 0
    v_dot2_f32_bf16 v10, v201, v25, v10
    v_dot2_f32_bf16 v10, v202, v26, v10
    v_dot2_f32_bf16 v10, v203, v27, v10
    v_add_f32_dpp v9, v9, v9 row_ror:8 row_mask:0xf bank_mask:0x3
    s_waitcnt lgkmcnt(0)
    v_readfirstlane_b32 s64, v62
    s_cmp_gt_u32 s64, 92
    s_nop 2
    s_cbranch_scc1 L_wk92
    s_waitcnt vmcnt(4)
L_wk92:
    s_waitcnt vmcnt(6)
    buffer_load_dwordx4 v[240:243], v2, s[40:43], s59 offen nt
    s_xor_b32 s59, s57, 0xce000
    v_mov_b32 v6, 92
    ds_write_b32 v7, v6 offset:272
    v_dot2_f32_bf16 v11, v204, v24, 0
    v_dot2_f32_bf16 v11, v205, v25, v11
    v_dot2_f32_bf16 v11, v206, v26, v11
    v_dot2_f32_bf16 v11, v207, v27, v11
    v_add_f32_dpp v10, v10, v10 row_ror:8 row_mask:0xf bank_mask:0x3
    s_cmp_gt_u32 s64, 93
    s_cbranch_scc1 L_wk93
    s_waitcnt vmcnt(4)
L_wk93:
    s_waitcnt vmcnt(6)
    buffer_load_dwordx4 v[244:247], v2, s[40:43], s59 offen nt
    s_xor_b32 s59, s57, 0xcd000
    ds_read_b32 v62, v7 offset:288
    v_mov_b32 v6, 93
    ds_write_b32 v7, v6 offset:272
    v_dot2_f32_bf16 v12, v208, v24, 0
    v_dot2_f32_bf16 v12, v209, v25, v12
    v_dot2_f32_bf16 v12, v210, v26, v12
    v_dot2_f32_bf16 v12, v211, v27, v12
    v_add_f32_dpp v11, v11, v11 row_ror:8 row_mask:0xf bank_mask:0x3
    s_waitcnt lgkmcnt(0)
    v_readfirstlane_b32 s64, v62
    s_cmp_gt_u32 s64, 94
    s_nop 2
    s_cbranch_scc1 L_wk94
    s_waitcnt vmcnt(4)
L_wk94:
    s_waitcnt vmcnt(6)
    buffer_load_dwordx4 v[248:251], v2, s[40:43], s59 offen nt
    s_xor_b32 s59, s57, 0xcf000
    v_mov_b32 v6, 94
    ds_write_b32 v7, v6 offset:272
    v_dot2_f32_bf16 v13, v212, v24, 0
    v_dot2_f32_bf16 v13, v213, v25, v13
    v_dot2_f32_bf16 v13, v214, v26, v13
    v_dot2_f32_bf16 v13, v215, v27, v13
    v_add_f32_dpp v12, v12, v12 row_ror:8 row_mask:0xf bank_mask:0x3
    s_cmp_gt_u32 s64, 95
    s_cbranch_scc1 L_wk95
    s_waitcnt vmcnt(4)
L_wk95:
    s_waitcnt vmcnt(6)
    buffer_load_dwordx4 v[252:255], v2, s[40:43], s59 offen nt
    s_xor_b32 s59, s57, 0xa0000
    ds_read_b32 v62, v7 offset:288
    v_mov_b32 v6, 95
    ds_write_b32 v7, v6 offset:272
    v_dot2_f32_bf16 v14, v216, v24, 0
    v_dot2_f32_bf16 v14, v217, v25, v14
    v_dot2_f32_bf16 v14, v218, v26, v14
    v_dot2_f32_bf16 v14, v219, v27, v14
    v_add_f32_dpp v13, v13, v13 row_ror:8 row_mask:0xf bank_mask:0x3
    s_waitcnt lgkmcnt(0)
    v_readfirstlane_b32 s64, v62
    s_cmp_gt_u32 s64, 96
    s_nop 2
    s_cbranch_scc1 L_wk96
    s_waitcnt vmcnt(4)
L_wk96:
    s_waitcnt vmcnt(6)
    buffer_load_dwordx4 v[64:67], v2, s[40:43], s59 offen nt
    s_xor_b32 s59, s57, 0xa2000
    v_mov_b32 v6, 96
    ds_write_b32 v7, v6 offset:272
    v_dot2_f32_bf16 v15, v220, v24, 0
    v_dot2_f32_bf16 v15, v221, v25, v15
    v_dot2_f32_bf16 v15, v222, v26, v15
    v_dot2_f32_bf16 v15, v223, v27, v15
    v_add_f32_dpp v14, v14, v14 row_ror:8 row_mask:0xf bank_mask:0x3
    s_cmp_gt_u32 s64, 97
    s_cbranch_scc1 L_wk97
    s_waitcnt vmcnt(4)
L_wk97:
    s_waitcnt vmcnt(6)
    buffer_load_dwordx4 v[68:71], v2, s[40:43], s59 offen nt
    s_xor_b32 s59, s57, 0xa1000
    ds_read_b32 v62, v7 offset:288
    v_mov_b32 v6, 97
    ds_write_b32 v7, v6 offset:272
    v_dot2_f32_bf16 v16, v224, v24, 0
    v_dot2_f32_bf16 v16, v225, v25, v16
    v_dot2_f32_bf16 v16, v226, v26, v16
    v_dot2_f32_bf16 v16, v227, v27, v16
    v_add_f32_dpp v15, v15, v15 row_ror:8 row_mask:0xf bank_mask:0x3
    s_waitcnt lgkmcnt(0)
    v_readfirstlane_b32 s64, v62
    s_cmp_gt_u32 s64, 98
    s_nop 2
    s_cbranch_scc1 L_wk98
    s_waitcnt vmcnt(4)
L_wk98:
    s_waitcnt vmcnt(6)
    buffer_load_dwordx4 v[72:75], v2, s[40:43], s59 offen nt
    s_xor_b32 s59, s57, 0xa3000
    v_mov_b32 v6, 98
    ds_write_b32 v7, v6 offset:272
    v_dot2_f32_bf16 v17, v228, v24, 0
    v_dot2_f32_bf16 v17, v229, v25, v17
    v_dot2_f32_bf16 v17, v230, v26, v17
    v_dot2_f32_bf16 v17, v231, v27, v17
    v_add_f32_dpp v8, v16, v16 row_ror:8 row_mask:0xf bank_mask:0xc
    s_cmp_gt_u32 s64, 99
    s_cbranch_scc1 L_wk99
    s_waitcnt vmcnt(4)
L_wk99:
    s_waitcnt vmcnt(6)
    buffer_load_dwordx4 v[76:79], v2, s[40:43], s59 offen nt
    s_xor_b32 s59, s57, 0xa4000
    ds_read_b32 v62, v7 offset:288
    v_mov_b32 v6, 99
    ds_write_b32 v7, v6 offset:272
    v_dot2_f32_bf16 v18, v232, v24, 0
    v_dot2_f32_bf16 v18, v233, v25, v18
    v_dot2_f32_bf16 v18, v234, v26, v18
    v_dot2_f32_bf16 v18, v235, v27, v18
    v_add_f32_dpp v9, v17, v17 row_ror:8 row_mask:0xf bank_mask:0xc
    s_waitcnt lgkmcnt(0)
    v_readfirstlane_b32 s64, v62
    s_cmp_gt_u32 s64, 100
    s_nop 2
    s_cbranch_scc1 L_wk100
    s_waitcnt vmcnt(4)
L_wk100:
    s_waitcnt vmcnt(6)
    buffer_load_dwordx4 v[80:83], v2, s[40:43], s59 offen nt
    s_xor_b32 s59, s57, 0xa6000
    v_mov_b32 v6, 100
    ds_write_b32 v7, v6 offset:272
    v_dot2_f32_bf16 v19, v236, v24, 0
    v_dot2_f32_bf16 v19, v237, v25, v19
    v_dot2_f32_bf16 v19, v238, v26, v19
    v_dot2_f32_bf16 v19, v239, v27, v19
    v_add_f32_dpp v10, v18, v18 row_ror:8 row_mask:0xf bank_mask:0xc
    s_cmp_gt_u32 s64, 101
    s_cbranch_scc1 L_wk101
    s_waitcnt vmcnt(4)
L_wk101:
    s_waitcnt vmcnt(6)
    buffer_load_dwordx4 v[84:87], v2, s[40:43], s59 offen nt
    s_xor_b32 s59, s57, 0xa5000
    ds_read_b32 v62, v7 offset:288
    v_mov_b32 v6, 101
    ds_write_b32 v7, v6 offset:272
    v_dot2_f32_bf16 v20, v240, v24, 0
    v_dot2_f32_bf16 v20, v241, v25, v20
    v_dot2_f32_bf16 v20, v242, v26, v20
    v_dot2_f32_bf16 v20, v243, v27, v20
    v_add_f32_dpp v11, v19, v19 row_ror:8 row_mask:0xf bank_mask:0xc
    s_waitcnt lgkmcnt(0)
    v_readfirstlane_b32 s64, v62
    s_cmp_gt_u32 s64, 102
    s_nop 2
    s_cbranch_scc1 L_wk102
    s_waitcnt vmcnt(4)
L_wk102:
    s_waitcnt vmcnt(6)
    buffer_load_dwordx4 v[88:91], v2, s[40:43], s59 offen nt
    s_xor_b32 s59, s57, 0xa7000
    v_mov_b32 v6, 102
    ds_write_b32 v7, v6 offset:272
    v_dot2_f32_bf16 v21, v244, v24, 0
    v_dot2_f32_bf16 v21, v245, v25, v21
    v_dot2_f32_bf16 v21, v246, v26, v21
    v_dot2_f32_bf16 v21, v247, v27, v21
    v_add_f32_dpp v12, v20, v20 row_ror:8 row_mask:0xf bank_mask:0xc
    s_cmp_gt_u32 s64, 103
    s_cbranch_scc1 L_wk103
    s_waitcnt vmcnt(4)
L_wk103:
    s_waitcnt vmcnt(6)
    buffer_load_dwordx4 v[92:95], v2, s[40:43], s59 offen nt
    s_xor_b32 s59, s57, 0xa8000
    ds_read_b32 v62, v7 offset:288
    v_mov_b32 v6, 103
    ds_write_b32 v7, v6 offset:272
    v_dot2_f32_bf16 v22, v248, v24, 0
    v_dot2_f32_bf16 v22, v249, v25, v22
    v_dot2_f32_bf16 v22, v250, v26, v22
    v_dot2_f32_bf16 v22, v251, v27, v22
    v_add_f32_dpp v13, v21, v21 row_ror:8 row_mask:0xf bank_mask:0xc
    s_waitcnt lgkmcnt(0)
    v_readfirstlane_b32 s64, v62
    s_cmp_gt_u32 s64, 104
    s_nop 2
    s_cbranch_scc1 L_wk104
    s_waitcnt vmcnt(4)
L_wk104:
    s_waitcnt vmcnt(6)
    buffer_load_dwordx4 v[96:99], v2, s[40:43], s59 offen nt
    s_xor_b32 s59, s57, 0xaa000
    v_mov_b32 v6, 104
    ds_write_b32 v7, v6 offset:272
    v_dot2_f32_bf16 v23, v252, v24, 0
    v_dot2_f32_bf16 v23, v253, v25, v23
    v_dot2_f32_bf16 v23, v254, v26, v23
    v_dot2_f32_bf16 v23, v255, v27, v23
    v_add_f32_dpp v14, v22, v22 row_ror:8 row_mask:0xf bank_mask:0xc
    s_cmp_gt_u32 s64, 105
    s_cbranch_scc1 L_wk105
    s_waitcnt vmcnt(4)
L_wk105:
    s_waitcnt vmcnt(6)
    buffer_load_dwordx4 v[100:103], v2, s[40:43], s59 offen nt
    s_xor_b32 s59, s57, 0xa9000
    ds_read_b32 v62, v7 offset:288
    v_mov_b32 v6, 105
    ds_write_b32 v7, v6 offset:272
    v_add_f32_dpp v15, v23, v23 row_ror:8 row_mask:0xf bank_mask:0xc
    v_add_f32_dpp v8, v8, v8 row_half_mirror row_mask:0xf bank_mask:0x5
    v_add_f32_dpp v9, v9, v9 row_half_mirror row_mask:0xf bank_mask:0x5
    v_add_f32_dpp v10, v10, v10 row_half_mirror row_mask:0xf bank_mask:0x5
    v_add_f32_dpp v11, v11, v11 row_half_mirror row_mask:0xf bank_mask:0x5
    v_add_f32_dpp v8, v12, v12 row_half_mirror row_mask:0xf bank_mask:0xa
    v_add_f32_dpp v9, v13, v13 row_half_mirror row_mask:0xf bank_mask:0xa
    v_add_f32_dpp v10, v14, v14 row_half_mirror row_mask:0xf bank_mask:0xa
    v_add_f32_dpp v11, v15, v15 row_half_mirror row_mask:0xf bank_mask:0xa
    v_add_f32_dpp v8, v8, v8 quad_perm:[2,3,0,1] row_mask:0xf bank_mask:0xf
    v_add_f32_dpp v9, v9, v9 quad_perm:[2,3,0,1] row_mask:0xf bank_mask:0xf
    v_add_f32_dpp v10, v10, v10 quad_perm:[2,3,0,1] row_mask:0xf bank_mask:0xf
    v_add_f32_dpp v11, v11, v11 quad_perm:[2,3,0,1] row_mask:0xf bank_mask:0xf
    v_cndmask_b32 v8, v8, v10, s[62:63]
    v_cndmask_b32 v9, v9, v11, s[62:63]
    s_nop 0
    v_add_f32_dpp v8, v8, v8 quad_perm:[1,0,3,2] row_mask:0xf bank_mask:0xf
    v_add_f32_dpp v9, v9, v9 quad_perm:[1,0,3,2] row_mask:0xf bank_mask:0xf
    v_cndmask_b32 v37, v8, v9, s[60:61]
    v_dot2_f32_bf16 v8, v64, v24, 0
    v_dot2_f32_bf16 v8, v65, v25, v8
    v_dot2_f32_bf16 v8, v66, v26, v8
    v_dot2_f32_bf16 v8, v67, v27, v8
    s_waitcnt lgkmcnt(0)
    v_readfirstlane_b32 s64, v62
    s_cmp_gt_u32 s64, 106
    s_nop 2
    s_cbranch_scc1 L_wk106
    s_waitcnt vmcnt(4)
L_wk106:
    s_waitcnt vmcnt(6)
    buffer_load_dwordx4 v[104:107], v2, s[40:43], s59 offen nt
    s_xor_b32 s59, s57, 0xab000
    v_mov_b32 v6, 106
    ds_write_b32 v7, v6 offset:272
    v_dot2_f32_bf16 v9, v68, v24, 0
    v_dot2_f32_bf16 v9, v69, v25, v9
    v_dot2_f32_bf16 v9, v70, v26, v9
    v_dot2_f32_bf16 v9, v71, v27, v9
    v_add_f32_dpp v8, v8, v8 row_ror:8 row_mask:0xf bank_mask:0x3
    s_cmp_gt_u32 s64, 107
    s_cbranch_scc1 L_wk107
    s_waitcnt vmcnt(4)
L_wk107:
    s_waitcnt vmcnt(6)
    buffer_load_dwordx4 v[108:111], v2, s[40:43], s59 offen nt
    s_xor_b32 s59, s57, 0xac000
    ds_read_b32 v62, v7 offset:288
    v_mov_b32 v6, 107
    ds_write_b32 v7, v6 offset:272
    v_dot2_f32_bf16 v10, v72, v24, 0
    v_dot2_f32_bf16 v10, v73, v25, v10
    v_dot2_f32_bf16 v10, v74, v26, v10
    v_dot2_f32_bf16 v10, v75, v27, v10
    v_add_f32_dpp v9, v9, v9 row_ror:8 row_mask:0xf bank_mask:0x3
    s_waitcnt lgkmcnt(0)
    v_readfirstlane_b32 s64, v62
    s_cmp_gt_u32 s64, 108
    s_nop 2
    s_cbranch_scc1 L_wk108
    s_waitcnt vmcnt(4)
L_wk108:
    s_waitcnt vmcnt(6)
    buffer_load_dwordx4 v[112:115], v2, s[40:43], s59 offen nt
    s_xor_b32 s59, s57, 0xae000
    v_mov_b32 v6, 108
    ds_write_b32 v7, v6 offset:272
    v_dot2_f32_bf16 v11, v76, v24, 0
    v_dot2_f32_bf16 v11, v77, v25, v11
    v_dot2_f32_bf16 v11, v78, v26, v11
    v_dot2_f32_bf16 v11, v79, v27, v11
    v_add_f32_dpp v10, v10, v10 row_ror:8 row_mask:0xf bank_mask:0x3
    s_cmp_gt_u32 s64, 109
    s_cbranch_scc1 L_wk109
    s_waitcnt vmcnt(4)
L_wk109:
    s_waitcnt vmcnt(6)
    buffer_load_dwordx4 v[116:119], v2, s[40:43], s59 offen nt
    s_xor_b32 s59, s57, 0xad000
    ds_read_b32 v62, v7 offset:288
    v_mov_b32 v6, 109
    ds_write_b32 v7, v6 offset:272
    v_dot2_f32_bf16 v12, v80, v24, 0
    v_dot2_f32_bf16 v12, v81, v25, v12
    v_dot2_f32_bf16 v12, v82, v26, v12
    v_dot2_f32_bf16 v12, v83, v27, v12
    v_add_f32_dpp v11, v11, v11 row_ror:8 row_mask:0xf bank_mask:0x3
    s_waitcnt lgkmcnt(0)
    v_readfirstlane_b32 s64, v62
    s_cmp_gt_u32 s64, 110
    s_nop 2
    s_cbranch_scc1 L_wk110
    s_waitcnt vmcnt(4)
L_wk110:
    s_waitcnt vmcnt(6)
    buffer_load_dwordx4 v[120:123], v2, s[40:43], s59 offen nt
    s_xor_b32 s59, s57, 0xaf000
    v_mov_b32 v6, 110
    ds_write_b32 v7, v6 offset:272
    v_dot2_f32_bf16 v13, v84, v24, 0
    v_dot2_f32_bf16 v13, v85, v25, v13
    v_dot2_f32_bf16 v13, v86, v26, v13
    v_dot2_f32_bf16 v13, v87, v27, v13
    v_add_f32_dpp v12, v12, v12 row_ror:8 row_mask:0xf bank_mask:0x3
    s_cmp_gt_u32 s64, 111
    s_cbranch_scc1 L_wk111
    s_waitcnt vmcnt(4)
L_wk111:
    s_waitcnt vmcnt(6)
    buffer_load_dwordx4 v[124:127], v2, s[40:43], s59 offen nt
    s_xor_b32 s59, s57, 0xe0000
    ds_read_b32 v62, v7 offset:288
    v_mov_b32 v6, 111
    ds_write_b32 v7, v6 offset:272
    v_dot2_f32_bf16 v14, v88, v24, 0
    v_dot2_f32_bf16 v14, v89, v25, v14
    v_dot2_f32_bf16 v14, v90, v26, v14
    v_dot2_f32_bf16 v14, v91, v27, v14
    v_add_f32_dpp v13, v13, v13 row_ror:8 row_mask:0xf bank_mask:0x3
    s_waitcnt lgkmcnt(0)
    v_readfirstlane_b32 s64, v62
    s_cmp_gt_u32 s64, 112
    s_nop 2
    s_cbranch_scc1 L_wk112
    s_waitcnt vmcnt(4)
L_wk112:
    s_waitcnt vmcnt(6)
    buffer_load_dwordx4 v[128:131], v2, s[40:43], s59 offen nt
    s_xor_b32 s59, s57, 0xe2000
    v_mov_b32 v6, 112
    ds_write_b32 v7, v6 offset:272
    v_dot2_f32_bf16 v15, v92, v24, 0
    v_dot2_f32_bf16 v15, v93, v25, v15
    v_dot2_f32_bf16 v15, v94, v26, v15
    v_dot2_f32_bf16 v15, v95, v27, v15
    v_add_f32_dpp v14, v14, v14 row_ror:8 row_mask:0xf bank_mask:0x3
    s_cmp_gt_u32 s64, 113
    s_cbranch_scc1 L_wk113
    s_waitcnt vmcnt(4)
L_wk113:
    s_waitcnt vmcnt(6)
    buffer_load_dwordx4 v[132:135], v2, s[40:43], s59 offen nt
    s_xor_b32 s59, s57, 0xe1000
    ds_read_b32 v62, v7 offset:288
    v_mov_b32 v6, 113
    ds_write_b32 v7, v6 offset:272
    v_dot2_f32_bf16 v16, v96, v24, 0
    v_dot2_f32_bf16 v16, v97, v25, v16
    v_dot2_f32_bf16 v16, v98, v26, v16
    v_dot2_f32_bf16 v16, v99, v27, v16
    v_add_f32_dpp v15, v15, v15 row_ror:8 row_mask:0xf bank_mask:0x3
    s_waitcnt lgkmcnt(0)
    v_readfirstlane_b32 s64, v62
    s_cmp_gt_u32 s64, 114
    s_nop 2
    s_cbranch_scc1 L_wk114
    s_waitcnt vmcnt(4)
L_wk114:
    s_waitcnt vmcnt(6)
    buffer_load_dwordx4 v[136:139], v2, s[40:43], s59 offen nt
    s_xor_b32 s59, s57, 0xe3000
    v_mov_b32 v6, 114
    ds_write_b32 v7, v6 offset:272
    v_dot2_f32_bf16 v17, v100, v24, 0
    v_dot2_f32_bf16 v17, v101, v25, v17
    v_dot2_f32_bf16 v17, v102, v26, v17
    v_dot2_f32_bf16 v17, v103, v27, v17
    v_add_f32_dpp v8, v16, v16 row_ror:8 row_mask:0xf bank_mask:0xc
    s_cmp_gt_u32 s64, 115
    s_cbranch_scc1 L_wk115
    s_waitcnt vmcnt(4)
L_wk115:
    s_waitcnt vmcnt(6)
    buffer_load_dwordx4 v[140:143], v2, s[40:43], s59 offen nt
    s_xor_b32 s59, s57, 0xe4000
    ds_read_b32 v62, v7 offset:288
    v_mov_b32 v6, 115
    ds_write_b32 v7, v6 offset:272
    v_dot2_f32_bf16 v18, v104, v24, 0
    v_dot2_f32_bf16 v18, v105, v25, v18
    v_dot2_f32_bf16 v18, v106, v26, v18
    v_dot2_f32_bf16 v18, v107, v27, v18
    v_add_f32_dpp v9, v17, v17 row_ror:8 row_mask:0xf bank_mask:0xc
    s_waitcnt lgkmcnt(0)
    v_readfirstlane_b32 s64, v62
    s_cmp_gt_u32 s64, 116
    s_nop 2
    s_cbranch_scc1 L_wk116
    s_waitcnt vmcnt(4)
L_wk116:
    s_waitcnt vmcnt(6)
    buffer_load_dwordx4 v[144:147], v2, s[40:43], s59 offen nt
    s_xor_b32 s59, s57, 0xe6000
    v_mov_b32 v6, 116
    ds_write_b32 v7, v6 offset:272
    v_dot2_f32_bf16 v19, v108, v24, 0
    v_dot2_f32_bf16 v19, v109, v25, v19
    v_dot2_f32_bf16 v19, v110, v26, v19
    v_dot2_f32_bf16 v19, v111, v27, v19
    v_add_f32_dpp v10, v18, v18 row_ror:8 row_mask:0xf bank_mask:0xc
    s_cmp_gt_u32 s64, 117
    s_cbranch_scc1 L_wk117
    s_waitcnt vmcnt(4)
L_wk117:
    s_waitcnt vmcnt(6)
    buffer_load_dwordx4 v[148:151], v2, s[40:43], s59 offen nt
    s_xor_b32 s59, s57, 0xe5000
    ds_read_b32 v62, v7 offset:288
    v_mov_b32 v6, 117
    ds_write_b32 v7, v6 offset:272
    v_dot2_f32_bf16 v20, v112, v24, 0
    v_dot2_f32_bf16 v20, v113, v25, v20
    v_dot2_f32_bf16 v20, v114, v26, v20
    v_dot2_f32_bf16 v20, v115, v27, v20
    v_add_f32_dpp v11, v19, v19 row_ror:8 row_mask:0xf bank_mask:0xc
    s_waitcnt lgkmcnt(0)
    v_readfirstlane_b32 s64, v62
    s_cmp_gt_u32 s64, 118
    s_nop 2
    s_cbranch_scc1 L_wk118
    s_waitcnt vmcnt(4)
L_wk118:
    s_waitcnt vmcnt(6)
    buffer_load_dwordx4 v[152:155], v2, s[40:43], s59 offen nt
    s_xor_b32 s59, s57, 0xe7000
    v_mov_b32 v6, 118
    ds_write_b32 v7, v6 offset:272
    v_dot2_f32_bf16 v21, v116, v24, 0
    v_dot2_f32_bf16 v21, v117, v25, v21
    v_dot2_f32_bf16 v21, v118, v26, v21
    v_dot2_f32_bf16 v21, v119, v27, v21
    v_add_f32_dpp v12, v20, v20 row_ror:8 row_mask:0xf bank_mask:0xc
    s_cmp_gt_u32 s64, 119
    s_cbranch_scc1 L_wk119
    s_waitcnt vmcnt(4)
L_wk119:
    s_waitcnt vmcnt(6)
    buffer_load_dwordx4 v[156:159], v2, s[40:43], s59 offen nt
    s_xor_b32 s59, s57, 0xe8000
    ds_read_b32 v62, v7 offset:288
    v_mov_b32 v6, 119
    ds_write_b32 v7, v6 offset:272
    v_dot2_f32_bf16 v22, v120, v24, 0
    v_dot2_f32_bf16 v22, v121, v25, v22
    v_dot2_f32_bf16 v22, v122, v26, v22
    v_dot2_f32_bf16 v22, v123, v27, v22
    v_add_f32_dpp v13, v21, v21 row_ror:8 row_mask:0xf bank_mask:0xc
    s_waitcnt lgkmcnt(0)
    v_readfirstlane_b32 s64, v62
    s_cmp_gt_u32 s64, 120
    s_nop 2
    s_cbranch_scc1 L_wk120
    s_waitcnt vmcnt(4)
L_wk120:
    s_waitcnt vmcnt(6)
    buffer_load_dwordx4 v[160:163], v2, s[40:43], s59 offen nt
    s_xor_b32 s59, s57, 0xea000
    v_mov_b32 v6, 120
    ds_write_b32 v7, v6 offset:272
    v_dot2_f32_bf16 v23, v124, v24, 0
    v_dot2_f32_bf16 v23, v125, v25, v23
    v_dot2_f32_bf16 v23, v126, v26, v23
    v_dot2_f32_bf16 v23, v127, v27, v23
    v_add_f32_dpp v14, v22, v22 row_ror:8 row_mask:0xf bank_mask:0xc
    s_cmp_gt_u32 s64, 121
    s_cbranch_scc1 L_wk121
    s_waitcnt vmcnt(4)
L_wk121:
    s_waitcnt vmcnt(6)
    buffer_load_dwordx4 v[164:167], v2, s[40:43], s59 offen nt
    s_xor_b32 s59, s57, 0xe9000
    ds_read_b32 v62, v7 offset:288
    v_mov_b32 v6, 121
    ds_write_b32 v7, v6 offset:272
    v_add_f32_dpp v15, v23, v23 row_ror:8 row_mask:0xf bank_mask:0xc
    v_add_f32_dpp v8, v8, v8 row_half_mirror row_mask:0xf bank_mask:0x5
    v_add_f32_dpp v9, v9, v9 row_half_mirror row_mask:0xf bank_mask:0x5
    v_add_f32_dpp v10, v10, v10 row_half_mirror row_mask:0xf bank_mask:0x5
    v_add_f32_dpp v11, v11, v11 row_half_mirror row_mask:0xf bank_mask:0x5
    v_add_f32_dpp v8, v12, v12 row_half_mirror row_mask:0xf bank_mask:0xa
    v_add_f32_dpp v9, v13, v13 row_half_mirror row_mask:0xf bank_mask:0xa
    v_add_f32_dpp v10, v14, v14 row_half_mirror row_mask:0xf bank_mask:0xa
    v_add_f32_dpp v11, v15, v15 row_half_mirror row_mask:0xf bank_mask:0xa
    v_add_f32_dpp v8, v8, v8 quad_perm:[2,3,0,1] row_mask:0xf bank_mask:0xf
    v_add_f32_dpp v9, v9, v9 quad_perm:[2,3,0,1] row_mask:0xf bank_mask:0xf
    v_add_f32_dpp v10, v10, v10 quad_perm:[2,3,0,1] row_mask:0xf bank_mask:0xf
    v_add_f32_dpp v11, v11, v11 quad_perm:[2,3,0,1] row_mask:0xf bank_mask:0xf
    v_cndmask_b32 v8, v8, v10, s[62:63]
    v_cndmask_b32 v9, v9, v11, s[62:63]
    s_nop 0
    v_add_f32_dpp v8, v8, v8 quad_perm:[1,0,3,2] row_mask:0xf bank_mask:0xf
    v_add_f32_dpp v9, v9, v9 quad_perm:[1,0,3,2] row_mask:0xf bank_mask:0xf
    v_cndmask_b32 v38, v8, v9, s[60:61]
    v_dot2_f32_bf16 v8, v128, v24, 0
    v_dot2_f32_bf16 v8, v129, v25, v8
    v_dot2_f32_bf16 v8, v130, v26, v8
    v_dot2_f32_bf16 v8, v131, v27, v8
    s_waitcnt lgkmcnt(0)
    v_readfirstlane_b32 s64, v62
    s_cmp_gt_u32 s64, 122
    s_nop 2
    s_cbranch_scc1 L_wk122
    s_waitcnt vmcnt(4)
L_wk122:
    s_waitcnt vmcnt(6)
    buffer_load_dwordx4 v[168:171], v2, s[40:43], s59 offen nt
    s_xor_b32 s59, s57, 0xeb000
    v_mov_b32 v6, 122
    ds_write_b32 v7, v6 offset:272
    v_dot2_f32_bf16 v9, v132, v24, 0
    v_dot2_f32_bf16 v9, v133, v25, v9
    v_dot2_f32_bf16 v9, v134, v26, v9
    v_dot2_f32_bf16 v9, v135, v27, v9
    v_add_f32_dpp v8, v8, v8 row_ror:8 row_mask:0xf bank_mask:0x3
    s_cmp_gt_u32 s64, 123
    s_cbranch_scc1 L_wk123
    s_waitcnt vmcnt(4)
L_wk123:
    s_waitcnt vmcnt(6)
    buffer_load_dwordx4 v[172:175], v2, s[40:43], s59 offen nt
    s_xor_b32 s59, s57, 0xec000
    ds_read_b32 v62, v7 offset:288
    v_mov_b32 v6, 123
    ds_write_b32 v7, v6 offset:272
    v_dot2_f32_bf16 v10, v136, v24, 0
    v_dot2_f32_bf16 v10, v137, v25, v10
    v_dot2_f32_bf16 v10, v138, v26, v10
    v_dot2_f32_bf16 v10, v139, v27, v10
    v_add_f32_dpp v9, v9, v9 row_ror:8 row_mask:0xf bank_mask:0x3
    s_waitcnt lgkmcnt(0)
    v_readfirstlane_b32 s64, v62
    s_cmp_gt_u32 s64, 124
    s_nop 2
    s_cbranch_scc1 L_wk124
    s_waitcnt vmcnt(4)
L_wk124:
    s_waitcnt vmcnt(6)
    buffer_load_dwordx4 v[176:179], v2, s[40:43], s59 offen nt
    s_xor_b32 s59, s57, 0xee000
    v_mov_b32 v6, 124
    ds_write_b32 v7, v6 offset:272
    v_dot2_f32_bf16 v11, v140, v24, 0
    v_dot2_f32_bf16 v11, v141, v25, v11
    v_dot2_f32_bf16 v11, v142, v26, v11
    v_dot2_f32_bf16 v11, v143, v27, v11
    v_add_f32_dpp v10, v10, v10 row_ror:8 row_mask:0xf bank_mask:0x3
    s_cmp_gt_u32 s64, 125
    s_cbranch_scc1 L_wk125
    s_waitcnt vmcnt(4)
L_wk125:
    s_waitcnt vmcnt(6)
    buffer_load_dwordx4 v[180:183], v2, s[40:43], s59 offen nt
    s_xor_b32 s59, s57, 0xed000
    ds_read_b32 v62, v7 offset:288
    v_mov_b32 v6, 125
    ds_write_b32 v7, v6 offset:272
    v_dot2_f32_bf16 v12, v144, v24, 0
    v_dot2_f32_bf16 v12, v145, v25, v12
    v_dot2_f32_bf16 v12, v146, v26, v12
    v_dot2_f32_bf16 v12, v147, v27, v12
    v_add_f32_dpp v11, v11, v11 row_ror:8 row_mask:0xf bank_mask:0x3
    s_waitcnt lgkmcnt(0)
    v_readfirstlane_b32 s64, v62
    s_cmp_gt_u32 s64, 126
    s_nop 2
    s_cbranch_scc1 L_wk126
    s_waitcnt vmcnt(4)
L_wk126:
    s_waitcnt vmcnt(6)
    buffer_load_dwordx4 v[184:187], v2, s[40:43], s59 offen nt
    s_xor_b32 s59, s57, 0xef000
    v_mov_b32 v6, 126
    ds_write_b32 v7, v6 offset:272
    v_dot2_f32_bf16 v13, v148, v24, 0
    v_dot2_f32_bf16 v13, v149, v25, v13
    v_dot2_f32_bf16 v13, v150, v26, v13
    v_dot2_f32_bf16 v13, v151, v27, v13
    v_add_f32_dpp v12, v12, v12 row_ror:8 row_mask:0xf bank_mask:0x3
    s_cmp_gt_u32 s64, 127
    s_cbranch_scc1 L_wk127
    s_waitcnt vmcnt(4)
L_wk127:
    s_waitcnt vmcnt(6)
    buffer_load_dwordx4 v[188:191], v2, s[40:43], s59 offen nt
    s_xor_b32 s59, s57, 0x0
    ds_read_b32 v62, v7 offset:288
    v_mov_b32 v6, 127
    ds_write_b32 v7, v6 offset:272
    v_dot2_f32_bf16 v14, v152, v24, 0
    v_dot2_f32_bf16 v14, v153, v25, v14
    v_dot2_f32_bf16 v14, v154, v26, v14
    v_dot2_f32_bf16 v14, v155, v27, v14
    v_add_f32_dpp v13, v13, v13 row_ror:8 row_mask:0xf bank_mask:0x3
    s_waitcnt lgkmcnt(0)
    v_readfirstlane_b32 s64, v62
    s_cmp_gt_u32 s64, 128
    s_nop 2
    s_cbranch_scc1 L_wk128
    s_waitcnt vmcnt(4)
L_wk128:
    s_waitcnt vmcnt(6)
    buffer_load_dwordx4 v[192:195], v2, s[48:51], s59 offen nt
    s_xor_b32 s59, s57, 0x2000
    v_mov_b32 v6, 128
    ds_write_b32 v7, v6 offset:272
    v_dot2_f32_bf16 v15, v156, v24, 0
    v_dot2_f32_bf16 v15, v157, v25, v15
    v_dot2_f32_bf16 v15, v158, v26, v15
    v_dot2_f32_bf16 v15, v159, v27, v15
    v_add_f32_dpp v14, v14, v14 row_ror:8 row_mask:0xf bank_mask:0x3
    s_cmp_gt_u32 s64, 129
    s_cbranch_scc1 L_wk129
    s_waitcnt vmcnt(4)
L_wk129:
    s_waitcnt vmcnt(6)
    buffer_load_dwordx4 v[196:199], v2, s[48:51], s59 offen nt
    s_xor_b32 s59, s57, 0x1000
    ds_read_b32 v62, v7 offset:288
    v_mov_b32 v6, 129
    ds_write_b32 v7, v6 offset:272
    v_dot2_f32_bf16 v16, v160, v24, 0
    v_dot2_f32_bf16 v16, v161, v25, v16
    v_dot2_f32_bf16 v16, v162, v26, v16
    v_dot2_f32_bf16 v16, v163, v27, v16
    v_add_f32_dpp v15, v15, v15 row_ror:8 row_mask:0xf bank_mask:0x3
    s_waitcnt lgkmcnt(0)
    v_readfirstlane_b32 s64, v62
    s_cmp_gt_u32 s64, 130
    s_nop 2
    s_cbranch_scc1 L_wk130
    s_waitcnt vmcnt(4)
L_wk130:
    s_waitcnt vmcnt(6)
    buffer_load_dwordx4 v[200:203], v2, s[48:51], s59 offen nt
    s_xor_b32 s59, s57, 0x3000
    v_mov_b32 v6, 130
    ds_write_b32 v7, v6 offset:272
    v_dot2_f32_bf16 v17, v164, v24, 0
    v_dot2_f32_bf16 v17, v165, v25, v17
    v_dot2_f32_bf16 v17, v166, v26, v17
    v_dot2_f32_bf16 v17, v167, v27, v17
    v_add_f32_dpp v8, v16, v16 row_ror:8 row_mask:0xf bank_mask:0xc
    s_cmp_gt_u32 s64, 131
    s_cbranch_scc1 L_wk131
    s_waitcnt vmcnt(4)
L_wk131:
    s_waitcnt vmcnt(6)
    buffer_load_dwordx4 v[204:207], v2, s[48:51], s59 offen nt
    s_xor_b32 s59, s57, 0x4000
    ds_read_b32 v62, v7 offset:288
    v_mov_b32 v6, 131
    ds_write_b32 v7, v6 offset:272
    v_dot2_f32_bf16 v18, v168, v24, 0
    v_dot2_f32_bf16 v18, v169, v25, v18
    v_dot2_f32_bf16 v18, v170, v26, v18
    v_dot2_f32_bf16 v18, v171, v27, v18
    v_add_f32_dpp v9, v17, v17 row_ror:8 row_mask:0xf bank_mask:0xc
    s_waitcnt lgkmcnt(0)
    v_readfirstlane_b32 s64, v62
    s_cmp_gt_u32 s64, 132
    s_nop 2
    s_cbranch_scc1 L_wk132
    s_waitcnt vmcnt(4)
L_wk132:
    s_waitcnt vmcnt(6)
    buffer_load_dwordx4 v[208:211], v2, s[48:51], s59 offen nt
    s_xor_b32 s59, s57, 0x6000
    v_mov_b32 v6, 132
    ds_write_b32 v7, v6 offset:272
    v_dot2_f32_bf16 v19, v172, v24, 0
    v_dot2_f32_bf16 v19, v173, v25, v19
    v_dot2_f32_bf16 v19, v174, v26, v19
    v_dot2_f32_bf16 v19, v175, v27, v19
    v_add_f32_dpp v10, v18, v18 row_ror:8 row_mask:0xf bank_mask:0xc
    s_cmp_gt_u32 s64, 133
    s_cbranch_scc1 L_wk133
    s_waitcnt vmcnt(4)
L_wk133:
    s_waitcnt vmcnt(6)
    buffer_load_dwordx4 v[212:215], v2, s[48:51], s59 offen nt
    s_xor_b32 s59, s57, 0x5000
    ds_read_b32 v62, v7 offset:288
    v_mov_b32 v6, 133
    ds_write_b32 v7, v6 offset:272
    v_dot2_f32_bf16 v20, v176, v24, 0
    v_dot2_f32_bf16 v20, v177, v25, v20
    v_dot2_f32_bf16 v20, v178, v26, v20
    v_dot2_f32_bf16 v20, v179, v27, v20
    v_add_f32_dpp v11, v19, v19 row_ror:8 row_mask:0xf bank_mask:0xc
    s_waitcnt lgkmcnt(0)
    v_readfirstlane_b32 s64, v62
    s_cmp_gt_u32 s64, 134
    s_nop 2
    s_cbranch_scc1 L_wk134
    s_waitcnt vmcnt(4)
L_wk134:
    s_waitcnt vmcnt(6)
    buffer_load_dwordx4 v[216:219], v2, s[48:51], s59 offen nt
    s_xor_b32 s59, s57, 0x7000
    v_mov_b32 v6, 134
    ds_write_b32 v7, v6 offset:272
    v_dot2_f32_bf16 v21, v180, v24, 0
    v_dot2_f32_bf16 v21, v181, v25, v21
    v_dot2_f32_bf16 v21, v182, v26, v21
    v_dot2_f32_bf16 v21, v183, v27, v21
    v_add_f32_dpp v12, v20, v20 row_ror:8 row_mask:0xf bank_mask:0xc
    s_cmp_gt_u32 s64, 135
    s_cbranch_scc1 L_wk135
    s_waitcnt vmcnt(4)
L_wk135:
    s_waitcnt vmcnt(6)
    buffer_load_dwordx4 v[220:223], v2, s[48:51], s59 offen nt
    s_xor_b32 s59, s57, 0x8000
    ds_read_b32 v62, v7 offset:288
    v_mov_b32 v6, 135
    ds_write_b32 v7, v6 offset:272
    v_dot2_f32_bf16 v22, v184, v24, 0
    v_dot2_f32_bf16 v22, v185, v25, v22
    v_dot2_f32_bf16 v22, v186, v26, v22
    v_dot2_f32_bf16 v22, v187, v27, v22
    v_add_f32_dpp v13, v21, v21 row_ror:8 row_mask:0xf bank_mask:0xc
    s_waitcnt lgkmcnt(0)
    v_readfirstlane_b32 s64, v62
    s_cmp_gt_u32 s64, 136
    s_nop 2
    s_cbranch_scc1 L_wk136
    s_waitcnt vmcnt(4)
L_wk136:
    s_waitcnt vmcnt(6)
    buffer_load_dwordx4 v[224:227], v2, s[48:51], s59 offen nt
    s_xor_b32 s59, s57, 0xa000
    v_mov_b32 v6, 136
    ds_write_b32 v7, v6 offset:272
    v_dot2_f32_bf16 v23, v188, v24, 0
    v_dot2_f32_bf16 v23, v189, v25, v23
    v_dot2_f32_bf16 v23, v190, v26, v23
    v_dot2_f32_bf16 v23, v191, v27, v23
    v_add_f32_dpp v14, v22, v22 row_ror:8 row_mask:0xf bank_mask:0xc
    s_cmp_gt_u32 s64, 137
    s_cbranch_scc1 L_wk137
    s_waitcnt vmcnt(4)
L_wk137:
    s_waitcnt vmcnt(6)
    buffer_load_dwordx4 v[228:231], v2, s[48:51], s59 offen nt
    s_xor_b32 s59, s57, 0x9000
    ds_read_b32 v62, v7 offset:288
    v_mov_b32 v6, 137
    ds_write_b32 v7, v6 offset:272
    v_add_f32_dpp v15, v23, v23 row_ror:8 row_mask:0xf bank_mask:0xc
    v_add_f32_dpp v8, v8, v8 row_half_mirror row_mask:0xf bank_mask:0x5
    v_add_f32_dpp v9, v9, v9 row_half_mirror row_mask:0xf bank_mask:0x5
    v_add_f32_dpp v10, v10, v10 row_half_mirror row_mask:0xf bank_mask:0x5
    v_add_f32_dpp v11, v11, v11 row_half_mirror row_mask:0xf bank_mask:0x5
    v_add_f32_dpp v8, v12, v12 row_half_mirror row_mask:0xf bank_mask:0xa
    v_add_f32_dpp v9, v13, v13 row_half_mirror row_mask:0xf bank_mask:0xa
    v_add_f32_dpp v10, v14, v14 row_half_mirror row_mask:0xf bank_mask:0xa
    v_add_f32_dpp v11, v15, v15 row_half_mirror row_mask:0xf bank_mask:0xa
    v_add_f32_dpp v8, v8, v8 quad_perm:[2,3,0,1] row_mask:0xf bank_mask:0xf
    v_add_f32_dpp v9, v9, v9 quad_perm:[2,3,0,1] row_mask:0xf bank_mask:0xf
    v_add_f32_dpp v10, v10, v10 quad_perm:[2,3,0,1] row_mask:0xf bank_mask:0xf
    v_add_f32_dpp v11, v11, v11 quad_perm:[2,3,0,1] row_mask:0xf bank_mask:0xf
    v_cndmask_b32 v8, v8, v10, s[62:63]
    v_cndmask_b32 v9, v9, v11, s[62:63]
    s_nop 0
    v_add_f32_dpp v8, v8, v8 quad_perm:[1,0,3,2] row_mask:0xf bank_mask:0xf
    v_add_f32_dpp v9, v9, v9 quad_perm:[1,0,3,2] row_mask:0xf bank_mask:0xf
    v_cndmask_b32 v39, v8, v9, s[60:61]
    v_cvt_pk_bf16_f32 v33, v32, v33
    v_lshlrev_b32 v32, 16, v33
    v_and_b32 v33, 0xffff0000, v33
    v_cvt_pk_bf16_f32 v35, v34, v35
    v_lshlrev_b32 v34, 16, v35
    v_and_b32 v35, 0xffff0000, v35
    v_cvt_pk_bf16_f32 v37, v36, v37
    v_lshlrev_b32 v36, 16, v37
    v_and_b32 v37, 0xffff0000, v37
    v_cvt_pk_bf16_f32 v39, v38, v39
    v_lshlrev_b32 v38, 16, v39
    v_and_b32 v39, 0xffff0000, v39
    v_mul_f32 v32, s65, v32
    v_mul_f32 v33, s65, v33
    v_mul_f32 v34, s65, v34
    v_mul_f32 v35, s65, v35
    v_mul_f32 v36, s65, v36
    v_mul_f32 v37, s65, v37
    v_mul_f32 v38, s65, v38
    v_mul_f32 v39, s65, v39
    s_waitcnt lgkmcnt(0)
    v_readfirstlane_b32 s64, v62
    s_cmp_gt_u32 s64, 138
    s_nop 2
    s_cbranch_scc1 L_wk138
    s_waitcnt vmcnt(4)
L_wk138:
    s_waitcnt vmcnt(6)
    buffer_load_dwordx4 v[232:235], v2, s[48:51], s59 offen nt
    s_xor_b32 s59, s57, 0xb000
    v_mov_b32 v6, 138
    ds_write_b32 v7, v6 offset:272
    v_cvt_pk_bf16_f32 v33, v32, v33
    v_lshlrev_b32 v32, 16, v33
    v_and_b32 v33, 0xffff0000, v33
    v_cvt_pk_bf16_f32 v35, v34, v35
    v_lshlrev_b32 v34, 16, v35
    v_and_b32 v35, 0xffff0000, v35
    v_cvt_pk_bf16_f32 v37, v36, v37
    v_lshlrev_b32 v36, 16, v37
    v_and_b32 v37, 0xffff0000, v37
    v_cvt_pk_bf16_f32 v39, v38, v39
    v_lshlrev_b32 v38, 16, v39
    v_and_b32 v39, 0xffff0000, v39
    v_max3_f32 v54, v32, v33, v34
    v_max3_f32 v54, v54, v35, v36
    v_max3_f32 v54, v54, v37, v38
    v_max_f32 v54, v54, v39
    s_nop 1
    v_max_f32_dpp v54, v54, v54 row_ror:8 row_mask:0xf bank_mask:0xf
    s_nop 1
    v_max_f32_dpp v54, v54, v54 row_ror:4 row_mask:0xf bank_mask:0xf
    s_nop 1
    v_max_f32_dpp v54, v54, v54 row_ror:2 row_mask:0xf bank_mask:0xf
    s_nop 1
    v_max_f32_dpp v54, v54, v54 row_ror:1 row_mask:0xf bank_mask:0xf
    v_mov_b32 v52, v54
    s_nop 1
    v_permlane16_swap_b32 v54, v52
    v_max_f32 v54, v54, v52
    v_mov_b32 v52, v54
    s_nop 1
    v_permlane32_swap_b32 v54, v52
    v_max_f32 v54, v54, v52
    v_mul_f32 v56, s66, v54
    v_fma_f32 v32, v32, s66, -v56
    v_fma_f32 v33, v33, s66, -v56
    v_fma_f32 v34, v34, s66, -v56
    v_fma_f32 v35, v35, s66, -v56
    v_fma_f32 v36, v36, s66, -v56
    v_fma_f32 v37, v37, s66, -v56
    v_fma_f32 v38, v38, s66, -v56
    v_fma_f32 v39, v39, s66, -v56
    v_exp_f32 v32, v32
    v_exp_f32 v33, v33
    v_exp_f32 v34, v34
    v_exp_f32 v35, v35
    v_exp_f32 v36, v36
    s_cmp_gt_u32 s64, 139
    s_cbranch_scc1 L_wk139
    s_waitcnt vmcnt(4)
L_wk139:
    s_waitcnt vmcnt(6)
    buffer_load_dwordx4 v[236:239], v2, s[48:51], s59 offen nt
    s_xor_b32 s59, s57, 0xc000
    ds_read_b32 v62, v7 offset:288
    v_mov_b32 v6, 139
    ds_write_b32 v7, v6 offset:272
    v_exp_f32 v37, v37
    v_exp_f32 v38, v38
    v_exp_f32 v39, v39
    v_add_f32 v55, v32, v33
    v_add_f32 v55, v55, v34
    v_add_f32 v55, v55, v35
    v_add_f32 v55, v55, v36
    v_add_f32 v55, v55, v37
    v_add_f32 v55, v55, v38
    v_add_f32 v55, v55, v39
    v_cvt_pk_bf16_f32 v32, v32, v32
    v_cvt_pk_bf16_f32 v33, v33, v33
    v_cvt_pk_bf16_f32 v34, v34, v34
    v_cvt_pk_bf16_f32 v35, v35, v35
    v_cvt_pk_bf16_f32 v36, v36, v36
    v_cvt_pk_bf16_f32 v37, v37, v37
    v_cvt_pk_bf16_f32 v38, v38, v38
    v_cvt_pk_bf16_f32 v39, v39, v39
    v_add_f32_dpp v55, v55, v55 row_ror:8 row_mask:0xf bank_mask:0xf
    s_nop 1
    v_add_f32_dpp v55, v55, v55 row_ror:4 row_mask:0xf bank_mask:0xf
    s_nop 1
    v_add_f32_dpp v55, v55, v55 row_ror:2 row_mask:0xf bank_mask:0xf
    s_nop 1
    v_add_f32_dpp v55, v55, v55 row_ror:1 row_mask:0xf bank_mask:0xf
    v_mov_b32 v52, v55
    s_nop 1
    v_permlane16_swap_b32 v55, v52
    v_add_f32 v55, v55, v52
    v_mov_b32 v52, v55
    s_nop 1
    v_permlane32_swap_b32 v55, v52
    v_add_f32 v55, v55, v52
    v_min_u32 v55, -2, v55
    s_lshl_b32 s39, s56, 3
    v_mov_b32 v52, s39
    ds_write_b64 v52, v[54:55] offset:3072
    v_and_b32 v3, 14, v1
    v_lshlrev_b32 v3, 4, v3
    v_and_b32 v4, 1, v1
    v_lshl_add_u32 v3, v4, 3, v3
    v_lshrrev_b32 v4, 4, v1
    v_lshl_add_u32 v3, v4, 2, v3
    s_lshl_b32 s39, s56, 8
    s_add_u32 s39, s39, 2048
    s_waitcnt lgkmcnt(0)
    v_readfirstlane_b32 s64, v62
    s_cmp_gt_u32 s64, 140
    s_nop 2
    s_cbranch_scc1 L_wk140
    s_waitcnt vmcnt(4)
L_wk140:
    s_waitcnt vmcnt(6)
    buffer_load_dwordx4 v[240:243], v2, s[48:51], s59 offen nt
    s_xor_b32 s59, s57, 0xe000
    v_mov_b32 v6, 140
    ds_write_b32 v7, v6 offset:272
    v_add_u32 v3, s39, v3
    v_and_b32_dpp v40, v32, v28 row_newbcast:0 row_mask:0xf bank_mask:0xf
    v_and_b32_dpp v41, v32, v29 row_newbcast:0 row_mask:0xf bank_mask:0xf
    v_and_b32_dpp v42, v32, v30 row_newbcast:0 row_mask:0xf bank_mask:0xf
    v_and_b32_dpp v43, v32, v31 row_newbcast:0 row_mask:0xf bank_mask:0xf
    s_nop 1
    v_mfma_f32_16x16x32_bf16 v[48:51], v[40:43], v[192:195], 0
    v_and_b32_dpp v44, v32, v28 row_newbcast:1 row_mask:0xf bank_mask:0xf
    v_and_b32_dpp v45, v32, v29 row_newbcast:1 row_mask:0xf bank_mask:0xf
    v_and_b32_dpp v46, v32, v30 row_newbcast:1 row_mask:0xf bank_mask:0xf
    v_and_b32_dpp v47, v32, v31 row_newbcast:1 row_mask:0xf bank_mask:0xf
    s_nop 1
    v_mfma_f32_16x16x32_bf16 v[48:51], v[44:47], v[196:199], v[48:51]
    v_and_b32_dpp v40, v32, v28 row_newbcast:2 row_mask:0xf bank_mask:0xf
    v_and_b32_dpp v41, v32, v29 row_newbcast:2 row_mask:0xf bank_mask:0xf
    v_and_b32_dpp v42, v32, v30 row_newbcast:2 row_mask:0xf bank_mask:0xf
    v_and_b32_dpp v43, v32, v31 row_newbcast:2 row_mask:0xf bank_mask:0xf
    s_cmp_gt_u32 s64, 141
    s_nop 1
    s_cbranch_scc1 L_wk141
    s_waitcnt vmcnt(4)
L_wk141:
    s_waitcnt vmcnt(6)
    buffer_load_dwordx4 v[244:247], v2, s[48:51], s59 offen nt
    s_xor_b32 s59, s57, 0xd000
    ds_read_b32 v62, v7 offset:288
    v_mov_b32 v6, 141
    ds_write_b32 v7, v6 offset:272
    v_mfma_f32_16x16x32_bf16 v[48:51], v[40:43], v[200:203], v[48:51]
    v_and_b32_dpp v44, v32, v28 row_newbcast:3 row_mask:0xf bank_mask:0xf
    v_and_b32_dpp v45, v32, v29 row_newbcast:3 row_mask:0xf bank_mask:0xf
    v_and_b32_dpp v46, v32, v30 row_newbcast:3 row_mask:0xf bank_mask:0xf
    v_and_b32_dpp v47, v32, v31 row_newbcast:3 row_mask:0xf bank_mask:0xf
    s_nop 1
    v_mfma_f32_16x16x32_bf16 v[48:51], v[44:47], v[204:207], v[48:51]
    v_and_b32_dpp v40, v32, v28 row_newbcast:4 row_mask:0xf bank_mask:0xf
    v_and_b32_dpp v41, v32, v29 row_newbcast:4 row_mask:0xf bank_mask:0xf
    v_and_b32_dpp v42, v32, v30 row_newbcast:4 row_mask:0xf bank_mask:0xf
    v_and_b32_dpp v43, v32, v31 row_newbcast:4 row_mask:0xf bank_mask:0xf
    s_waitcnt lgkmcnt(0)
    v_readfirstlane_b32 s64, v62
    s_cmp_gt_u32 s64, 142
    s_nop 2
    s_cbranch_scc1 L_wk142
    s_waitcnt vmcnt(4)
L_wk142:
    s_waitcnt vmcnt(6)
    buffer_load_dwordx4 v[248:251], v2, s[48:51], s59 offen nt
    s_xor_b32 s59, s57, 0xf000
    v_mov_b32 v6, 142
    ds_write_b32 v7, v6 offset:272
    v_mfma_f32_16x16x32_bf16 v[48:51], v[40:43], v[208:211], v[48:51]
    v_and_b32_dpp v44, v32, v28 row_newbcast:5 row_mask:0xf bank_mask:0xf
    v_and_b32_dpp v45, v32, v29 row_newbcast:5 row_mask:0xf bank_mask:0xf
    v_and_b32_dpp v46, v32, v30 row_newbcast:5 row_mask:0xf bank_mask:0xf
    v_and_b32_dpp v47, v32, v31 row_newbcast:5 row_mask:0xf bank_mask:0xf
    s_nop 1
    v_mfma_f32_16x16x32_bf16 v[48:51], v[44:47], v[212:215], v[48:51]
    v_and_b32_dpp v40, v32, v28 row_newbcast:6 row_mask:0xf bank_mask:0xf
    v_and_b32_dpp v41, v32, v29 row_newbcast:6 row_mask:0xf bank_mask:0xf
    v_and_b32_dpp v42, v32, v30 row_newbcast:6 row_mask:0xf bank_mask:0xf
    v_and_b32_dpp v43, v32, v31 row_newbcast:6 row_mask:0xf bank_mask:0xf
    s_cmp_gt_u32 s64, 143
    s_nop 1
    s_cbranch_scc1 L_wk143
    s_waitcnt vmcnt(4)
L_wk143:
    s_waitcnt vmcnt(6)
    buffer_load_dwordx4 v[252:255], v2, s[48:51], s59 offen nt
    s_xor_b32 s59, s57, 0x40000
    ds_read_b32 v62, v7 offset:288
    v_mov_b32 v6, 143
    ds_write_b32 v7, v6 offset:272
    v_mfma_f32_16x16x32_bf16 v[48:51], v[40:43], v[216:219], v[48:51]
    v_and_b32_dpp v44, v32, v28 row_newbcast:7 row_mask:0xf bank_mask:0xf
    v_and_b32_dpp v45, v32, v29 row_newbcast:7 row_mask:0xf bank_mask:0xf
    v_and_b32_dpp v46, v32, v30 row_newbcast:7 row_mask:0xf bank_mask:0xf
    v_and_b32_dpp v47, v32, v31 row_newbcast:7 row_mask:0xf bank_mask:0xf
    s_waitcnt lgkmcnt(0)
    v_readfirstlane_b32 s64, v62
    s_cmp_gt_u32 s64, 144
    s_nop 2
    s_cbranch_scc1 L_wk144
    s_waitcnt vmcnt(4)
L_wk144:
    s_waitcnt vmcnt(6)
    buffer_load_dwordx4 v[64:67], v2, s[48:51], s59 offen nt
    s_xor_b32 s59, s57, 0x42000
    v_mov_b32 v6, 144
    ds_write_b32 v7, v6 offset:272
    v_mfma_f32_16x16x32_bf16 v[48:51], v[44:47], v[220:223], v[48:51]
    v_and_b32_dpp v40, v32, v28 row_newbcast:8 row_mask:0xf bank_mask:0xf
    v_and_b32_dpp v41, v32, v29 row_newbcast:8 row_mask:0xf bank_mask:0xf
    v_and_b32_dpp v42, v32, v30 row_newbcast:8 row_mask:0xf bank_mask:0xf
    v_and_b32_dpp v43, v32, v31 row_newbcast:8 row_mask:0xf bank_mask:0xf
    s_cmp_gt_u32 s64, 145
    s_nop 1
    s_cbranch_scc1 L_wk145
    s_waitcnt vmcnt(4)
L_wk145:
    s_waitcnt vmcnt(6)
    buffer_load_dwordx4 v[68:71], v2, s[48:51], s59 offen nt
    s_xor_b32 s59, s57, 0x41000
    ds_read_b32 v62, v7 offset:288
    v_mov_b32 v6, 145
    ds_write_b32 v7, v6 offset:272
    v_mfma_f32_16x16x32_bf16 v[48:51], v[40:43], v[224:227], v[48:51]
    v_and_b32_dpp v44, v32, v28 row_newbcast:9 row_mask:0xf bank_mask:0xf
    v_and_b32_dpp v45, v32, v29 row_newbcast:9 row_mask:0xf bank_mask:0xf
    v_and_b32_dpp v46, v32, v30 row_newbcast:9 row_mask:0xf bank_mask:0xf
    v_and_b32_dpp v47, v32, v31 row_newbcast:9 row_mask:0xf bank_mask:0xf
    s_waitcnt lgkmcnt(0)
    v_readfirstlane_b32 s64, v62
    s_cmp_gt_u32 s64, 146
    s_nop 2
    s_cbranch_scc1 L_wk146
    s_waitcnt vmcnt(4)
L_wk146:
    s_waitcnt vmcnt(6)
    buffer_load_dwordx4 v[72:75], v2, s[48:51], s59 offen nt
    s_xor_b32 s59, s57, 0x43000
    v_mov_b32 v6, 146
    ds_write_b32 v7, v6 offset:272
    v_mfma_f32_16x16x32_bf16 v[48:51], v[44:47], v[228:231], v[48:51]
    v_and_b32_dpp v40, v32, v28 row_newbcast:10 row_mask:0xf bank_mask:0xf
    v_and_b32_dpp v41, v32, v29 row_newbcast:10 row_mask:0xf bank_mask:0xf
    v_and_b32_dpp v42, v32, v30 row_newbcast:10 row_mask:0xf bank_mask:0xf
    v_and_b32_dpp v43, v32, v31 row_newbcast:10 row_mask:0xf bank_mask:0xf
    s_cmp_gt_u32 s64, 147
    s_nop 1
    s_cbranch_scc1 L_wk147
    s_waitcnt vmcnt(4)
L_wk147:
    s_waitcnt vmcnt(6)
    buffer_load_dwordx4 v[76:79], v2, s[48:51], s59 offen nt
    s_xor_b32 s59, s57, 0x44000
    ds_read_b32 v62, v7 offset:288
    v_mov_b32 v6, 147
    ds_write_b32 v7, v6 offset:272
    v_mfma_f32_16x16x32_bf16 v[48:51], v[40:43], v[232:235], v[48:51]
    v_and_b32_dpp v44, v32, v28 row_newbcast:11 row_mask:0xf bank_mask:0xf
    v_and_b32_dpp v45, v32, v29 row_newbcast:11 row_mask:0xf bank_mask:0xf
    v_and_b32_dpp v46, v32, v30 row_newbcast:11 row_mask:0xf bank_mask:0xf
    v_and_b32_dpp v47, v32, v31 row_newbcast:11 row_mask:0xf bank_mask:0xf
    s_waitcnt lgkmcnt(0)
    v_readfirstlane_b32 s64, v62
    s_cmp_gt_u32 s64, 148
    s_nop 2
    s_cbranch_scc1 L_wk148
    s_waitcnt vmcnt(4)
L_wk148:
    s_waitcnt vmcnt(6)
    buffer_load_dwordx4 v[80:83], v2, s[48:51], s59 offen nt
    s_xor_b32 s59, s57, 0x46000
    v_mov_b32 v6, 148
    ds_write_b32 v7, v6 offset:272
    v_mfma_f32_16x16x32_bf16 v[48:51], v[44:47], v[236:239], v[48:51]
    v_and_b32_dpp v40, v32, v28 row_newbcast:12 row_mask:0xf bank_mask:0xf
    v_and_b32_dpp v41, v32, v29 row_newbcast:12 row_mask:0xf bank_mask:0xf
    v_and_b32_dpp v42, v32, v30 row_newbcast:12 row_mask:0xf bank_mask:0xf
    v_and_b32_dpp v43, v32, v31 row_newbcast:12 row_mask:0xf bank_mask:0xf
    s_cmp_gt_u32 s64, 149
    s_nop 1
    s_cbranch_scc1 L_wk149
    s_waitcnt vmcnt(4)
L_wk149:
    s_waitcnt vmcnt(6)
    buffer_load_dwordx4 v[84:87], v2, s[48:51], s59 offen nt
    s_xor_b32 s59, s57, 0x45000
    ds_read_b32 v62, v7 offset:288
    v_mov_b32 v6, 149
    ds_write_b32 v7, v6 offset:272
    v_mfma_f32_16x16x32_bf16 v[48:51], v[40:43], v[240:243], v[48:51]
    v_and_b32_dpp v44, v32, v28 row_newbcast:13 row_mask:0xf bank_mask:0xf
    v_and_b32_dpp v45, v32, v29 row_newbcast:13 row_mask:0xf bank_mask:0xf
    v_and_b32_dpp v46, v32, v30 row_newbcast:13 row_mask:0xf bank_mask:0xf
    v_and_b32_dpp v47, v32, v31 row_newbcast:13 row_mask:0xf bank_mask:0xf
    s_waitcnt lgkmcnt(0)
    v_readfirstlane_b32 s64, v62
    s_cmp_gt_u32 s64, 150
    s_nop 2
    s_cbranch_scc1 L_wk150
    s_waitcnt vmcnt(4)
L_wk150:
    s_waitcnt vmcnt(6)
    buffer_load_dwordx4 v[88:91], v2, s[48:51], s59 offen nt
    s_xor_b32 s59, s57, 0x47000
    v_mov_b32 v6, 150
    ds_write_b32 v7, v6 offset:272
    v_mfma_f32_16x16x32_bf16 v[48:51], v[44:47], v[244:247], v[48:51]
    v_and_b32_dpp v40, v32, v28 row_newbcast:14 row_mask:0xf bank_mask:0xf
    v_and_b32_dpp v41, v32, v29 row_newbcast:14 row_mask:0xf bank_mask:0xf
    v_and_b32_dpp v42, v32, v30 row_newbcast:14 row_mask:0xf bank_mask:0xf
    v_and_b32_dpp v43, v32, v31 row_newbcast:14 row_mask:0xf bank_mask:0xf
    s_cmp_gt_u32 s64, 151
    s_nop 1
    s_cbranch_scc1 L_wk151
    s_waitcnt vmcnt(4)
L_wk151:
    s_waitcnt vmcnt(6)
    buffer_load_dwordx4 v[92:95], v2, s[48:51], s59 offen nt
    s_xor_b32 s59, s57, 0x48000
    ds_read_b32 v62, v7 offset:288
    v_mov_b32 v6, 151
    ds_write_b32 v7, v6 offset:272
    v_mfma_f32_16x16x32_bf16 v[48:51], v[40:43], v[248:251], v[48:51]
    v_and_b32_dpp v44, v32, v28 row_newbcast:15 row_mask:0xf bank_mask:0xf
    v_and_b32_dpp v45, v32, v29 row_newbcast:15 row_mask:0xf bank_mask:0xf
    v_and_b32_dpp v46, v32, v30 row_newbcast:15 row_mask:0xf bank_mask:0xf
    v_and_b32_dpp v47, v32, v31 row_newbcast:15 row_mask:0xf bank_mask:0xf
    s_waitcnt lgkmcnt(0)
    v_readfirstlane_b32 s64, v62
    s_cmp_gt_u32 s64, 152
    s_nop 2
    s_cbranch_scc1 L_wk152
    s_waitcnt vmcnt(4)
L_wk152:
    s_waitcnt vmcnt(6)
    buffer_load_dwordx4 v[96:99], v2, s[48:51], s59 offen nt
    s_xor_b32 s59, s57, 0x4a000
    v_mov_b32 v6, 152
    ds_write_b32 v7, v6 offset:272
    v_mfma_f32_16x16x32_bf16 v[48:51], v[44:47], v[252:255], v[48:51]
    v_and_b32_dpp v40, v33, v28 row_newbcast:0 row_mask:0xf bank_mask:0xf
    v_and_b32_dpp v41, v33, v29 row_newbcast:0 row_mask:0xf bank_mask:0xf
    v_and_b32_dpp v42, v33, v30 row_newbcast:0 row_mask:0xf bank_mask:0xf
    v_and_b32_dpp v43, v33, v31 row_newbcast:0 row_mask:0xf bank_mask:0xf
    s_cmp_gt_u32 s64, 153
    s_nop 1
    s_cbranch_scc1 L_wk153
    s_waitcnt vmcnt(4)
L_wk153:
    s_waitcnt vmcnt(6)
    buffer_load_dwordx4 v[100:103], v2, s[48:51], s59 offen nt
    s_xor_b32 s59, s57, 0x49000
    ds_read_b32 v62, v7 offset:288
    v_mov_b32 v6, 153
    ds_write_b32 v7, v6 offset:272
    v_mfma_f32_16x16x32_bf16 v[48:51], v[40:43], v[64:67], v[48:51]
    v_and_b32_dpp v44, v33, v28 row_newbcast:1 row_mask:0xf bank_mask:0xf
    v_and_b32_dpp v45, v33, v29 row_newbcast:1 row_mask:0xf bank_mask:0xf
    v_and_b32_dpp v46, v33, v30 row_newbcast:1 row_mask:0xf bank_mask:0xf
    v_and_b32_dpp v47, v33, v31 row_newbcast:1 row_mask:0xf bank_mask:0xf
    s_waitcnt lgkmcnt(0)
    v_readfirstlane_b32 s64, v62
    s_cmp_gt_u32 s64, 154
    s_nop 2
    s_cbranch_scc1 L_wk154
    s_waitcnt vmcnt(4)
L_wk154:
    s_waitcnt vmcnt(6)
    buffer_load_dwordx4 v[104:107], v2, s[48:51], s59 offen nt
    s_xor_b32 s59, s57, 0x4b000
    v_mov_b32 v6, 154
    ds_write_b32 v7, v6 offset:272
    v_mfma_f32_16x16x32_bf16 v[48:51], v[44:47], v[68:71], v[48:51]
    v_and_b32_dpp v40, v33, v28 row_newbcast:2 row_mask:0xf bank_mask:0xf
    v_and_b32_dpp v41, v33, v29 row_newbcast:2 row_mask:0xf bank_mask:0xf
    v_and_b32_dpp v42, v33, v30 row_newbcast:2 row_mask:0xf bank_mask:0xf
    v_and_b32_dpp v43, v33, v31 row_newbcast:2 row_mask:0xf bank_mask:0xf
    s_cmp_gt_u32 s64, 155
    s_nop 1
    s_cbranch_scc1 L_wk155
    s_waitcnt vmcnt(4)
L_wk155:
    s_waitcnt vmcnt(6)
    buffer_load_dwordx4 v[108:111], v2, s[48:51], s59 offen nt
    s_xor_b32 s59, s57, 0x4c000
    ds_read_b32 v62, v7 offset:288
    v_mov_b32 v6, 155
    ds_write_b32 v7, v6 offset:272
    v_mfma_f32_16x16x32_bf16 v[48:51], v[40:43], v[72:75], v[48:51]
    v_and_b32_dpp v44, v33, v28 row_newbcast:3 row_mask:0xf bank_mask:0xf
    v_and_b32_dpp v45, v33, v29 row_newbcast:3 row_mask:0xf bank_mask:0xf
    v_and_b32_dpp v46, v33, v30 row_newbcast:3 row_mask:0xf bank_mask:0xf
    v_and_b32_dpp v47, v33, v31 row_newbcast:3 row_mask:0xf bank_mask:0xf
    s_waitcnt lgkmcnt(0)
    v_readfirstlane_b32 s64, v62
    s_cmp_gt_u32 s64, 156
    s_nop 2
    s_cbranch_scc1 L_wk156
    s_waitcnt vmcnt(4)
L_wk156:
    s_waitcnt vmcnt(6)
    buffer_load_dwordx4 v[112:115], v2, s[48:51], s59 offen nt
    s_xor_b32 s59, s57, 0x4e000
    v_mov_b32 v6, 156
    ds_write_b32 v7, v6 offset:272
    v_mfma_f32_16x16x32_bf16 v[48:51], v[44:47], v[76:79], v[48:51]
    v_and_b32_dpp v40, v33, v28 row_newbcast:4 row_mask:0xf bank_mask:0xf
    v_and_b32_dpp v41, v33, v29 row_newbcast:4 row_mask:0xf bank_mask:0xf
    v_and_b32_dpp v42, v33, v30 row_newbcast:4 row_mask:0xf bank_mask:0xf
    v_and_b32_dpp v43, v33, v31 row_newbcast:4 row_mask:0xf bank_mask:0xf
    s_cmp_gt_u32 s64, 157
    s_nop 1
    s_cbranch_scc1 L_wk157
    s_waitcnt vmcnt(4)
L_wk157:
    s_waitcnt vmcnt(6)
    buffer_load_dwordx4 v[116:119], v2, s[48:51], s59 offen nt
    s_xor_b32 s59, s57, 0x4d000
    ds_read_b32 v62, v7 offset:288
    v_mov_b32 v6, 157
    ds_write_b32 v7, v6 offset:272
    v_mfma_f32_16x16x32_bf16 v[48:51], v[40:43], v[80:83], v[48:51]
    v_and_b32_dpp v44, v33, v28 row_newbcast:5 row_mask:0xf bank_mask:0xf
    v_and_b32_dpp v45, v33, v29 row_newbcast:5 row_mask:0xf bank_mask:0xf
    v_and_b32_dpp v46, v33, v30 row_newbcast:5 row_mask:0xf bank_mask:0xf
    v_and_b32_dpp v47, v33, v31 row_newbcast:5 row_mask:0xf bank_mask:0xf
    s_waitcnt lgkmcnt(0)
    v_readfirstlane_b32 s64, v62
    s_cmp_gt_u32 s64, 158
    s_nop 2
    s_cbranch_scc1 L_wk158
    s_waitcnt vmcnt(4)
L_wk158:
    s_waitcnt vmcnt(6)
    buffer_load_dwordx4 v[120:123], v2, s[48:51], s59 offen nt
    s_xor_b32 s59, s57, 0x4f000
    v_mov_b32 v6, 158
    ds_write_b32 v7, v6 offset:272
    v_mfma_f32_16x16x32_bf16 v[48:51], v[44:47], v[84:87], v[48:51]
    v_and_b32_dpp v40, v33, v28 row_newbcast:6 row_mask:0xf bank_mask:0xf
    v_and_b32_dpp v41, v33, v29 row_newbcast:6 row_mask:0xf bank_mask:0xf
    v_and_b32_dpp v42, v33, v30 row_newbcast:6 row_mask:0xf bank_mask:0xf
    v_and_b32_dpp v43, v33, v31 row_newbcast:6 row_mask:0xf bank_mask:0xf
    s_cmp_gt_u32 s64, 159
    s_nop 1
    s_cbranch_scc1 L_wk159
    s_waitcnt vmcnt(4)
L_wk159:
    s_waitcnt vmcnt(6)
    buffer_load_dwordx4 v[124:127], v2, s[48:51], s59 offen nt
    s_xor_b32 s59, s57, 0x20000
    ds_read_b32 v62, v7 offset:288
    v_mov_b32 v6, 159
    ds_write_b32 v7, v6 offset:272
    v_mfma_f32_16x16x32_bf16 v[48:51], v[40:43], v[88:91], v[48:51]
    v_and_b32_dpp v44, v33, v28 row_newbcast:7 row_mask:0xf bank_mask:0xf
    v_and_b32_dpp v45, v33, v29 row_newbcast:7 row_mask:0xf bank_mask:0xf
    v_and_b32_dpp v46, v33, v30 row_newbcast:7 row_mask:0xf bank_mask:0xf
    v_and_b32_dpp v47, v33, v31 row_newbcast:7 row_mask:0xf bank_mask:0xf
    s_waitcnt lgkmcnt(0)
    v_readfirstlane_b32 s64, v62
    s_cmp_gt_u32 s64, 160
    s_nop 2
    s_cbranch_scc1 L_wk160
    s_waitcnt vmcnt(4)
L_wk160:
    s_waitcnt vmcnt(6)
    buffer_load_dwordx4 v[128:131], v2, s[48:51], s59 offen nt
    s_xor_b32 s59, s57, 0x22000
    v_mov_b32 v6, 160
    ds_write_b32 v7, v6 offset:272
    v_mfma_f32_16x16x32_bf16 v[48:51], v[44:47], v[92:95], v[48:51]
    v_and_b32_dpp v40, v33, v28 row_newbcast:8 row_mask:0xf bank_mask:0xf
    v_and_b32_dpp v41, v33, v29 row_newbcast:8 row_mask:0xf bank_mask:0xf
    v_and_b32_dpp v42, v33, v30 row_newbcast:8 row_mask:0xf bank_mask:0xf
    v_and_b32_dpp v43, v33, v31 row_newbcast:8 row_mask:0xf bank_mask:0xf
    s_cmp_gt_u32 s64, 161
    s_nop 1
    s_cbranch_scc1 L_wk161
    s_waitcnt vmcnt(4)
L_wk161:
    s_waitcnt vmcnt(6)
    buffer_load_dwordx4 v[132:135], v2, s[48:51], s59 offen nt
    s_xor_b32 s59, s57, 0x21000
    ds_read_b32 v62, v7 offset:288
    v_mov_b32 v6, 161
    ds_write_b32 v7, v6 offset:272
    v_mfma_f32_16x16x32_bf16 v[48:51], v[40:43], v[96:99], v[48:51]
    v_and_b32_dpp v44, v33, v28 row_newbcast:9 row_mask:0xf bank_mask:0xf
    v_and_b32_dpp v45, v33, v29 row_newbcast:9 row_mask:0xf bank_mask:0xf
    v_and_b32_dpp v46, v33, v30 row_newbcast:9 row_mask:0xf bank_mask:0xf
    v_and_b32_dpp v47, v33, v31 row_newbcast:9 row_mask:0xf bank_mask:0xf
    s_waitcnt lgkmcnt(0)
    v_readfirstlane_b32 s64, v62
    s_cmp_gt_u32 s64, 162
    s_nop 2
    s_cbranch_scc1 L_wk162
    s_waitcnt vmcnt(4)
L_wk162:
    s_waitcnt vmcnt(6)
    buffer_load_dwordx4 v[136:139], v2, s[48:51], s59 offen nt
    s_xor_b32 s59, s57, 0x23000
    v_mov_b32 v6, 162
    ds_write_b32 v7, v6 offset:272
    v_mfma_f32_16x16x32_bf16 v[48:51], v[44:47], v[100:103], v[48:51]
    v_and_b32_dpp v40, v33, v28 row_newbcast:10 row_mask:0xf bank_mask:0xf
    v_and_b32_dpp v41, v33, v29 row_newbcast:10 row_mask:0xf bank_mask:0xf
    v_and_b32_dpp v42, v33, v30 row_newbcast:10 row_mask:0xf bank_mask:0xf
    v_and_b32_dpp v43, v33, v31 row_newbcast:10 row_mask:0xf bank_mask:0xf
    s_cmp_gt_u32 s64, 163
    s_nop 1
    s_cbranch_scc1 L_wk163
    s_waitcnt vmcnt(4)
L_wk163:
    s_waitcnt vmcnt(6)
    buffer_load_dwordx4 v[140:143], v2, s[48:51], s59 offen nt
    s_xor_b32 s59, s57, 0x24000
    ds_read_b32 v62, v7 offset:288
    v_mov_b32 v6, 163
    ds_write_b32 v7, v6 offset:272
    v_mfma_f32_16x16x32_bf16 v[48:51], v[40:43], v[104:107], v[48:51]
    v_and_b32_dpp v44, v33, v28 row_newbcast:11 row_mask:0xf bank_mask:0xf
    v_and_b32_dpp v45, v33, v29 row_newbcast:11 row_mask:0xf bank_mask:0xf
    v_and_b32_dpp v46, v33, v30 row_newbcast:11 row_mask:0xf bank_mask:0xf
    v_and_b32_dpp v47, v33, v31 row_newbcast:11 row_mask:0xf bank_mask:0xf
    s_waitcnt lgkmcnt(0)
    v_readfirstlane_b32 s64, v62
    s_cmp_gt_u32 s64, 164
    s_nop 2
    s_cbranch_scc1 L_wk164
    s_waitcnt vmcnt(4)
L_wk164:
    s_waitcnt vmcnt(6)
    buffer_load_dwordx4 v[144:147], v2, s[48:51], s59 offen nt
    s_xor_b32 s59, s57, 0x26000
    v_mov_b32 v6, 164
    ds_write_b32 v7, v6 offset:272
    v_mfma_f32_16x16x32_bf16 v[48:51], v[44:47], v[108:111], v[48:51]
    v_and_b32_dpp v40, v33, v28 row_newbcast:12 row_mask:0xf bank_mask:0xf
    v_and_b32_dpp v41, v33, v29 row_newbcast:12 row_mask:0xf bank_mask:0xf
    v_and_b32_dpp v42, v33, v30 row_newbcast:12 row_mask:0xf bank_mask:0xf
    v_and_b32_dpp v43, v33, v31 row_newbcast:12 row_mask:0xf bank_mask:0xf
    s_cmp_gt_u32 s64, 165
    s_nop 1
    s_cbranch_scc1 L_wk165
    s_waitcnt vmcnt(4)
L_wk165:
    s_waitcnt vmcnt(6)
    buffer_load_dwordx4 v[148:151], v2, s[48:51], s59 offen nt
    s_xor_b32 s59, s57, 0x25000
    ds_read_b32 v62, v7 offset:288
    v_mov_b32 v6, 165
    ds_write_b32 v7, v6 offset:272
    v_mfma_f32_16x16x32_bf16 v[48:51], v[40:43], v[112:115], v[48:51]
    v_and_b32_dpp v44, v33, v28 row_newbcast:13 row_mask:0xf bank_mask:0xf
    v_and_b32_dpp v45, v33, v29 row_newbcast:13 row_mask:0xf bank_mask:0xf
    v_and_b32_dpp v46, v33, v30 row_newbcast:13 row_mask:0xf bank_mask:0xf
    v_and_b32_dpp v47, v33, v31 row_newbcast:13 row_mask:0xf bank_mask:0xf
    s_waitcnt lgkmcnt(0)
    v_readfirstlane_b32 s64, v62
    s_cmp_gt_u32 s64, 166
    s_nop 2
    s_cbranch_scc1 L_wk166
    s_waitcnt vmcnt(4)
L_wk166:
    s_waitcnt vmcnt(6)
    buffer_load_dwordx4 v[152:155], v2, s[48:51], s59 offen nt
    s_xor_b32 s59, s57, 0x27000
    v_mov_b32 v6, 166
    ds_write_b32 v7, v6 offset:272
    v_mfma_f32_16x16x32_bf16 v[48:51], v[44:47], v[116:119], v[48:51]
    v_and_b32_dpp v40, v33, v28 row_newbcast:14 row_mask:0xf bank_mask:0xf
    v_and_b32_dpp v41, v33, v29 row_newbcast:14 row_mask:0xf bank_mask:0xf
    v_and_b32_dpp v42, v33, v30 row_newbcast:14 row_mask:0xf bank_mask:0xf
    v_and_b32_dpp v43, v33, v31 row_newbcast:14 row_mask:0xf bank_mask:0xf
    s_cmp_gt_u32 s64, 167
    s_nop 1
    s_cbranch_scc1 L_wk167
    s_waitcnt vmcnt(4)
L_wk167:
    s_waitcnt vmcnt(6)
    buffer_load_dwordx4 v[156:159], v2, s[48:51], s59 offen nt
    s_xor_b32 s59, s57, 0x28000
    ds_read_b32 v62, v7 offset:288
    v_mov_b32 v6, 167
    ds_write_b32 v7, v6 offset:272
    v_mfma_f32_16x16x32_bf16 v[48:51], v[40:43], v[120:123], v[48:51]
    v_and_b32_dpp v44, v33, v28 row_newbcast:15 row_mask:0xf bank_mask:0xf
    v_and_b32_dpp v45, v33, v29 row_newbcast:15 row_mask:0xf bank_mask:0xf
    v_and_b32_dpp v46, v33, v30 row_newbcast:15 row_mask:0xf bank_mask:0xf
    v_and_b32_dpp v47, v33, v31 row_newbcast:15 row_mask:0xf bank_mask:0xf
    s_waitcnt lgkmcnt(0)
    v_readfirstlane_b32 s64, v62
    s_cmp_gt_u32 s64, 168
    s_nop 2
    s_cbranch_scc1 L_wk168
    s_waitcnt vmcnt(4)
L_wk168:
    s_waitcnt vmcnt(6)
    buffer_load_dwordx4 v[160:163], v2, s[48:51], s59 offen nt
    s_xor_b32 s59, s57, 0x2a000
    v_mov_b32 v6, 168
    ds_write_b32 v7, v6 offset:272
    v_mfma_f32_16x16x32_bf16 v[48:51], v[44:47], v[124:127], v[48:51]
    v_and_b32_dpp v40, v34, v28 row_newbcast:0 row_mask:0xf bank_mask:0xf
    v_and_b32_dpp v41, v34, v29 row_newbcast:0 row_mask:0xf bank_mask:0xf
    v_and_b32_dpp v42, v34, v30 row_newbcast:0 row_mask:0xf bank_mask:0xf
    v_and_b32_dpp v43, v34, v31 row_newbcast:0 row_mask:0xf bank_mask:0xf
    s_cmp_gt_u32 s64, 169
    s_nop 1
    s_cbranch_scc1 L_wk169
    s_waitcnt vmcnt(4)
L_wk169:
    s_waitcnt vmcnt(6)
    buffer_load_dwordx4 v[164:167], v2, s[48:51], s59 offen nt
    s_xor_b32 s59, s57, 0x29000
    ds_read_b32 v62, v7 offset:288
    v_mov_b32 v6, 169
    ds_write_b32 v7, v6 offset:272
    v_mfma_f32_16x16x32_bf16 v[48:51], v[40:43], v[128:131], v[48:51]
    v_and_b32_dpp v44, v34, v28 row_newbcast:1 row_mask:0xf bank_mask:0xf
    v_and_b32_dpp v45, v34, v29 row_newbcast:1 row_mask:0xf bank_mask:0xf
    v_and_b32_dpp v46, v34, v30 row_newbcast:1 row_mask:0xf bank_mask:0xf
    v_and_b32_dpp v47, v34, v31 row_newbcast:1 row_mask:0xf bank_mask:0xf
    s_waitcnt lgkmcnt(0)
    v_readfirstlane_b32 s64, v62
    s_cmp_gt_u32 s64, 170
    s_nop 2
    s_cbranch_scc1 L_wk170
    s_waitcnt vmcnt(4)
L_wk170:
    s_waitcnt vmcnt(6)
    buffer_load_dwordx4 v[168:171], v2, s[48:51], s59 offen nt
    s_xor_b32 s59, s57, 0x2b000
    v_mov_b32 v6, 170
    ds_write_b32 v7, v6 offset:272
    v_mfma_f32_16x16x32_bf16 v[48:51], v[44:47], v[132:135], v[48:51]
    v_and_b32_dpp v40, v34, v28 row_newbcast:2 row_mask:0xf bank_mask:0xf
    v_and_b32_dpp v41, v34, v29 row_newbcast:2 row_mask:0xf bank_mask:0xf
    v_and_b32_dpp v42, v34, v30 row_newbcast:2 row_mask:0xf bank_mask:0xf
    v_and_b32_dpp v43, v34, v31 row_newbcast:2 row_mask:0xf bank_mask:0xf
    s_cmp_gt_u32 s64, 171
    s_nop 1
    s_cbranch_scc1 L_wk171
    s_waitcnt vmcnt(4)
L_wk171:
    s_waitcnt vmcnt(6)
    buffer_load_dwordx4 v[172:175], v2, s[48:51], s59 offen nt
    s_xor_b32 s59, s57, 0x2c000
    ds_read_b32 v62, v7 offset:288
    v_mov_b32 v6, 171
    ds_write_b32 v7, v6 offset:272
    v_mfma_f32_16x16x32_bf16 v[48:51], v[40:43], v[136:139], v[48:51]
    v_and_b32_dpp v44, v34, v28 row_newbcast:3 row_mask:0xf bank_mask:0xf
    v_and_b32_dpp v45, v34, v29 row_newbcast:3 row_mask:0xf bank_mask:0xf
    v_and_b32_dpp v46, v34, v30 row_newbcast:3 row_mask:0xf bank_mask:0xf
    v_and_b32_dpp v47, v34, v31 row_newbcast:3 row_mask:0xf bank_mask:0xf
    s_waitcnt lgkmcnt(0)
    v_readfirstlane_b32 s64, v62
    s_cmp_gt_u32 s64, 172
    s_nop 2
    s_cbranch_scc1 L_wk172
    s_waitcnt vmcnt(4)
L_wk172:
    s_waitcnt vmcnt(6)
    buffer_load_dwordx4 v[176:179], v2, s[48:51], s59 offen nt
    s_xor_b32 s59, s57, 0x2e000
    v_mov_b32 v6, 172
    ds_write_b32 v7, v6 offset:272
    v_mfma_f32_16x16x32_bf16 v[48:51], v[44:47], v[140:143], v[48:51]
    v_and_b32_dpp v40, v34, v28 row_newbcast:4 row_mask:0xf bank_mask:0xf
    v_and_b32_dpp v41, v34, v29 row_newbcast:4 row_mask:0xf bank_mask:0xf
    v_and_b32_dpp v42, v34, v30 row_newbcast:4 row_mask:0xf bank_mask:0xf
    v_and_b32_dpp v43, v34, v31 row_newbcast:4 row_mask:0xf bank_mask:0xf
    s_cmp_gt_u32 s64, 173
    s_nop 1
    s_cbranch_scc1 L_wk173
    s_waitcnt vmcnt(4)
L_wk173:
    s_waitcnt vmcnt(6)
    buffer_load_dwordx4 v[180:183], v2, s[48:51], s59 offen nt
    s_xor_b32 s59, s57, 0x2d000
    ds_read_b32 v62, v7 offset:288
    v_mov_b32 v6, 173
    ds_write_b32 v7, v6 offset:272
    v_mfma_f32_16x16x32_bf16 v[48:51], v[40:43], v[144:147], v[48:51]
    v_and_b32_dpp v44, v34, v28 row_newbcast:5 row_mask:0xf bank_mask:0xf
    v_and_b32_dpp v45, v34, v29 row_newbcast:5 row_mask:0xf bank_mask:0xf
    v_and_b32_dpp v46, v34, v30 row_newbcast:5 row_mask:0xf bank_mask:0xf
    v_and_b32_dpp v47, v34, v31 row_newbcast:5 row_mask:0xf bank_mask:0xf
    s_waitcnt lgkmcnt(0)
    v_readfirstlane_b32 s64, v62
    s_cmp_gt_u32 s64, 174
    s_nop 2
    s_cbranch_scc1 L_wk174
    s_waitcnt vmcnt(4)
L_wk174:
    s_waitcnt vmcnt(6)
    buffer_load_dwordx4 v[184:187], v2, s[48:51], s59 offen nt
    s_xor_b32 s59, s57, 0x2f000
    v_mov_b32 v6, 174
    ds_write_b32 v7, v6 offset:272
    v_mfma_f32_16x16x32_bf16 v[48:51], v[44:47], v[148:151], v[48:51]
    v_and_b32_dpp v40, v34, v28 row_newbcast:6 row_mask:0xf bank_mask:0xf
    v_and_b32_dpp v41, v34, v29 row_newbcast:6 row_mask:0xf bank_mask:0xf
    v_and_b32_dpp v42, v34, v30 row_newbcast:6 row_mask:0xf bank_mask:0xf
    v_and_b32_dpp v43, v34, v31 row_newbcast:6 row_mask:0xf bank_mask:0xf
    s_cmp_gt_u32 s64, 175
    s_nop 1
    s_cbranch_scc1 L_wk175
    s_waitcnt vmcnt(4)
L_wk175:
    s_waitcnt vmcnt(6)
    buffer_load_dwordx4 v[188:191], v2, s[48:51], s59 offen nt
    s_xor_b32 s59, s57, 0x60000
    ds_read_b32 v62, v7 offset:288
    v_mov_b32 v6, 175
    ds_write_b32 v7, v6 offset:272
    v_mfma_f32_16x16x32_bf16 v[48:51], v[40:43], v[152:155], v[48:51]
    v_and_b32_dpp v44, v34, v28 row_newbcast:7 row_mask:0xf bank_mask:0xf
    v_and_b32_dpp v45, v34, v29 row_newbcast:7 row_mask:0xf bank_mask:0xf
    v_and_b32_dpp v46, v34, v30 row_newbcast:7 row_mask:0xf bank_mask:0xf
    v_and_b32_dpp v47, v34, v31 row_newbcast:7 row_mask:0xf bank_mask:0xf
    s_waitcnt lgkmcnt(0)
    v_readfirstlane_b32 s64, v62
    s_cmp_gt_u32 s64, 176
    s_nop 2
    s_cbranch_scc1 L_wk176
    s_waitcnt vmcnt(4)
L_wk176:
    s_waitcnt vmcnt(6)
    buffer_load_dwordx4 v[192:195], v2, s[48:51], s59 offen nt
    s_xor_b32 s59, s57, 0x62000
    v_mov_b32 v6, 176
    ds_write_b32 v7, v6 offset:272
    v_mfma_f32_16x16x32_bf16 v[48:51], v[44:47], v[156:159], v[48:51]
    v_and_b32_dpp v40, v34, v28 row_newbcast:8 row_mask:0xf bank_mask:0xf
    v_and_b32_dpp v41, v34, v29 row_newbcast:8 row_mask:0xf bank_mask:0xf
    v_and_b32_dpp v42, v34, v30 row_newbcast:8 row_mask:0xf bank_mask:0xf
    v_and_b32_dpp v43, v34, v31 row_newbcast:8 row_mask:0xf bank_mask:0xf
    s_cmp_gt_u32 s64, 177
    s_nop 1
    s_cbranch_scc1 L_wk177
    s_waitcnt vmcnt(4)
L_wk177:
    s_waitcnt vmcnt(6)
    buffer_load_dwordx4 v[196:199], v2, s[48:51], s59 offen nt
    s_xor_b32 s59, s57, 0x61000
    ds_read_b32 v62, v7 offset:288
    v_mov_b32 v6, 177
    ds_write_b32 v7, v6 offset:272
    v_mfma_f32_16x16x32_bf16 v[48:51], v[40:43], v[160:163], v[48:51]
    v_and_b32_dpp v44, v34, v28 row_newbcast:9 row_mask:0xf bank_mask:0xf
    v_and_b32_dpp v45, v34, v29 row_newbcast:9 row_mask:0xf bank_mask:0xf
    v_and_b32_dpp v46, v34, v30 row_newbcast:9 row_mask:0xf bank_mask:0xf
    v_and_b32_dpp v47, v34, v31 row_newbcast:9 row_mask:0xf bank_mask:0xf
    s_waitcnt lgkmcnt(0)
    v_readfirstlane_b32 s64, v62
    s_cmp_gt_u32 s64, 178
    s_nop 2
    s_cbranch_scc1 L_wk178
    s_waitcnt vmcnt(4)
L_wk178:
    s_waitcnt vmcnt(6)
    buffer_load_dwordx4 v[200:203], v2, s[48:51], s59 offen nt
    s_xor_b32 s59, s57, 0x63000
    v_mov_b32 v6, 178
    ds_write_b32 v7, v6 offset:272
    v_mfma_f32_16x16x32_bf16 v[48:51], v[44:47], v[164:167], v[48:51]
    v_and_b32_dpp v40, v34, v28 row_newbcast:10 row_mask:0xf bank_mask:0xf
    v_and_b32_dpp v41, v34, v29 row_newbcast:10 row_mask:0xf bank_mask:0xf
    v_and_b32_dpp v42, v34, v30 row_newbcast:10 row_mask:0xf bank_mask:0xf
    v_and_b32_dpp v43, v34, v31 row_newbcast:10 row_mask:0xf bank_mask:0xf
    s_cmp_gt_u32 s64, 179
    s_nop 1
    s_cbranch_scc1 L_wk179
    s_waitcnt vmcnt(4)
L_wk179:
    s_waitcnt vmcnt(6)
    buffer_load_dwordx4 v[204:207], v2, s[48:51], s59 offen nt
    s_xor_b32 s59, s57, 0x64000
    ds_read_b32 v62, v7 offset:288
    v_mov_b32 v6, 179
    ds_write_b32 v7, v6 offset:272
    v_mfma_f32_16x16x32_bf16 v[48:51], v[40:43], v[168:171], v[48:51]
    v_and_b32_dpp v44, v34, v28 row_newbcast:11 row_mask:0xf bank_mask:0xf
    v_and_b32_dpp v45, v34, v29 row_newbcast:11 row_mask:0xf bank_mask:0xf
    v_and_b32_dpp v46, v34, v30 row_newbcast:11 row_mask:0xf bank_mask:0xf
    v_and_b32_dpp v47, v34, v31 row_newbcast:11 row_mask:0xf bank_mask:0xf
    s_waitcnt lgkmcnt(0)
    v_readfirstlane_b32 s64, v62
    s_cmp_gt_u32 s64, 180
    s_nop 2
    s_cbranch_scc1 L_wk180
    s_waitcnt vmcnt(4)
L_wk180:
    s_waitcnt vmcnt(6)
    buffer_load_dwordx4 v[208:211], v2, s[48:51], s59 offen nt
    s_xor_b32 s59, s57, 0x66000
    v_mov_b32 v6, 180
    ds_write_b32 v7, v6 offset:272
    v_mfma_f32_16x16x32_bf16 v[48:51], v[44:47], v[172:175], v[48:51]
    v_and_b32_dpp v40, v34, v28 row_newbcast:12 row_mask:0xf bank_mask:0xf
    v_and_b32_dpp v41, v34, v29 row_newbcast:12 row_mask:0xf bank_mask:0xf
    v_and_b32_dpp v42, v34, v30 row_newbcast:12 row_mask:0xf bank_mask:0xf
    v_and_b32_dpp v43, v34, v31 row_newbcast:12 row_mask:0xf bank_mask:0xf
    s_cmp_gt_u32 s64, 181
    s_nop 1
    s_cbranch_scc1 L_wk181
    s_waitcnt vmcnt(4)
L_wk181:
    s_waitcnt vmcnt(6)
    buffer_load_dwordx4 v[212:215], v2, s[48:51], s59 offen nt
    s_xor_b32 s59, s57, 0x65000
    ds_read_b32 v62, v7 offset:288
    v_mov_b32 v6, 181
    ds_write_b32 v7, v6 offset:272
    v_mfma_f32_16x16x32_bf16 v[48:51], v[40:43], v[176:179], v[48:51]
    v_and_b32_dpp v44, v34, v28 row_newbcast:13 row_mask:0xf bank_mask:0xf
    v_and_b32_dpp v45, v34, v29 row_newbcast:13 row_mask:0xf bank_mask:0xf
    v_and_b32_dpp v46, v34, v30 row_newbcast:13 row_mask:0xf bank_mask:0xf
    v_and_b32_dpp v47, v34, v31 row_newbcast:13 row_mask:0xf bank_mask:0xf
    s_waitcnt lgkmcnt(0)
    v_readfirstlane_b32 s64, v62
    s_cmp_gt_u32 s64, 182
    s_nop 2
    s_cbranch_scc1 L_wk182
    s_waitcnt vmcnt(4)
L_wk182:
    s_waitcnt vmcnt(6)
    buffer_load_dwordx4 v[216:219], v2, s[48:51], s59 offen nt
    s_xor_b32 s59, s57, 0x67000
    v_mov_b32 v6, 182
    ds_write_b32 v7, v6 offset:272
    v_mfma_f32_16x16x32_bf16 v[48:51], v[44:47], v[180:183], v[48:51]
    v_and_b32_dpp v40, v34, v28 row_newbcast:14 row_mask:0xf bank_mask:0xf
    v_and_b32_dpp v41, v34, v29 row_newbcast:14 row_mask:0xf bank_mask:0xf
    v_and_b32_dpp v42, v34, v30 row_newbcast:14 row_mask:0xf bank_mask:0xf
    v_and_b32_dpp v43, v34, v31 row_newbcast:14 row_mask:0xf bank_mask:0xf
    s_cmp_gt_u32 s64, 183
    s_nop 1
    s_cbranch_scc1 L_wk183
    s_waitcnt vmcnt(4)
L_wk183:
    s_waitcnt vmcnt(6)
    buffer_load_dwordx4 v[220:223], v2, s[48:51], s59 offen nt
    s_xor_b32 s59, s57, 0x68000
    ds_read_b32 v62, v7 offset:288
    v_mov_b32 v6, 183
    ds_write_b32 v7, v6 offset:272
    v_mfma_f32_16x16x32_bf16 v[48:51], v[40:43], v[184:187], v[48:51]
    v_and_b32_dpp v44, v34, v28 row_newbcast:15 row_mask:0xf bank_mask:0xf
    v_and_b32_dpp v45, v34, v29 row_newbcast:15 row_mask:0xf bank_mask:0xf
    v_and_b32_dpp v46, v34, v30 row_newbcast:15 row_mask:0xf bank_mask:0xf
    v_and_b32_dpp v47, v34, v31 row_newbcast:15 row_mask:0xf bank_mask:0xf
    s_waitcnt lgkmcnt(0)
    v_readfirstlane_b32 s64, v62
    s_cmp_gt_u32 s64, 184
    s_nop 2
    s_cbranch_scc1 L_wk184
    s_waitcnt vmcnt(4)
L_wk184:
    s_waitcnt vmcnt(6)
    buffer_load_dwordx4 v[224:227], v2, s[48:51], s59 offen nt
    s_xor_b32 s59, s57, 0x6a000
    v_mov_b32 v6, 184
    ds_write_b32 v7, v6 offset:272
    v_mfma_f32_16x16x32_bf16 v[48:51], v[44:47], v[188:191], v[48:51]
    v_and_b32_dpp v40, v35, v28 row_newbcast:0 row_mask:0xf bank_mask:0xf
    v_and_b32_dpp v41, v35, v29 row_newbcast:0 row_mask:0xf bank_mask:0xf
    v_and_b32_dpp v42, v35, v30 row_newbcast:0 row_mask:0xf bank_mask:0xf
    v_and_b32_dpp v43, v35, v31 row_newbcast:0 row_mask:0xf bank_mask:0xf
    s_cmp_gt_u32 s64, 185
    s_nop 1
    s_cbranch_scc1 L_wk185
    s_waitcnt vmcnt(4)
L_wk185:
    s_waitcnt vmcnt(6)
    buffer_load_dwordx4 v[228:231], v2, s[48:51], s59 offen nt
    s_xor_b32 s59, s57, 0x69000
    ds_read_b32 v62, v7 offset:288
    v_mov_b32 v6, 185
    ds_write_b32 v7, v6 offset:272
    v_mfma_f32_16x16x32_bf16 v[48:51], v[40:43], v[192:195], v[48:51]
    v_and_b32_dpp v44, v35, v28 row_newbcast:1 row_mask:0xf bank_mask:0xf
    v_and_b32_dpp v45, v35, v29 row_newbcast:1 row_mask:0xf bank_mask:0xf
    v_and_b32_dpp v46, v35, v30 row_newbcast:1 row_mask:0xf bank_mask:0xf
    v_and_b32_dpp v47, v35, v31 row_newbcast:1 row_mask:0xf bank_mask:0xf
    s_waitcnt lgkmcnt(0)
    v_readfirstlane_b32 s64, v62
    s_cmp_gt_u32 s64, 186
    s_nop 2
    s_cbranch_scc1 L_wk186
    s_waitcnt vmcnt(4)
L_wk186:
    s_waitcnt vmcnt(6)
    buffer_load_dwordx4 v[232:235], v2, s[48:51], s59 offen nt
    s_xor_b32 s59, s57, 0x6b000
    v_mov_b32 v6, 186
    ds_write_b32 v7, v6 offset:272
    v_mfma_f32_16x16x32_bf16 v[48:51], v[44:47], v[196:199], v[48:51]
    v_and_b32_dpp v40, v35, v28 row_newbcast:2 row_mask:0xf bank_mask:0xf
    v_and_b32_dpp v41, v35, v29 row_newbcast:2 row_mask:0xf bank_mask:0xf
    v_and_b32_dpp v42, v35, v30 row_newbcast:2 row_mask:0xf bank_mask:0xf
    v_and_b32_dpp v43, v35, v31 row_newbcast:2 row_mask:0xf bank_mask:0xf
    s_cmp_gt_u32 s64, 187
    s_nop 1
    s_cbranch_scc1 L_wk187
    s_waitcnt vmcnt(4)
L_wk187:
    s_waitcnt vmcnt(6)
    buffer_load_dwordx4 v[236:239], v2, s[48:51], s59 offen nt
    s_xor_b32 s59, s57, 0x6c000
    ds_read_b32 v62, v7 offset:288
    v_mov_b32 v6, 187
    ds_write_b32 v7, v6 offset:272
    v_mfma_f32_16x16x32_bf16 v[48:51], v[40:43], v[200:203], v[48:51]
    v_and_b32_dpp v44, v35, v28 row_newbcast:3 row_mask:0xf bank_mask:0xf
    v_and_b32_dpp v45, v35, v29 row_newbcast:3 row_mask:0xf bank_mask:0xf
    v_and_b32_dpp v46, v35, v30 row_newbcast:3 row_mask:0xf bank_mask:0xf
    v_and_b32_dpp v47, v35, v31 row_newbcast:3 row_mask:0xf bank_mask:0xf
    s_waitcnt lgkmcnt(0)
    v_readfirstlane_b32 s64, v62
    s_cmp_gt_u32 s64, 188
    s_nop 2
    s_cbranch_scc1 L_wk188
    s_waitcnt vmcnt(4)
L_wk188:
    s_waitcnt vmcnt(6)
    buffer_load_dwordx4 v[240:243], v2, s[48:51], s59 offen nt
    s_xor_b32 s59, s57, 0x6e000
    v_mov_b32 v6, 188
    ds_write_b32 v7, v6 offset:272
    v_mfma_f32_16x16x32_bf16 v[48:51], v[44:47], v[204:207], v[48:51]
    v_and_b32_dpp v40, v35, v28 row_newbcast:4 row_mask:0xf bank_mask:0xf
    v_and_b32_dpp v41, v35, v29 row_newbcast:4 row_mask:0xf bank_mask:0xf
    v_and_b32_dpp v42, v35, v30 row_newbcast:4 row_mask:0xf bank_mask:0xf
    v_and_b32_dpp v43, v35, v31 row_newbcast:4 row_mask:0xf bank_mask:0xf
    s_cmp_gt_u32 s64, 189
    s_nop 1
    s_cbranch_scc1 L_wk189
    s_waitcnt vmcnt(4)
L_wk189:
    s_waitcnt vmcnt(6)
    buffer_load_dwordx4 v[244:247], v2, s[48:51], s59 offen nt
    s_xor_b32 s59, s57, 0x6d000
    ds_read_b32 v62, v7 offset:288
    v_mov_b32 v6, 189
    ds_write_b32 v7, v6 offset:272
    v_mfma_f32_16x16x32_bf16 v[48:51], v[40:43], v[208:211], v[48:51]
    v_and_b32_dpp v44, v35, v28 row_newbcast:5 row_mask:0xf bank_mask:0xf
    v_and_b32_dpp v45, v35, v29 row_newbcast:5 row_mask:0xf bank_mask:0xf
    v_and_b32_dpp v46, v35, v30 row_newbcast:5 row_mask:0xf bank_mask:0xf
    v_and_b32_dpp v47, v35, v31 row_newbcast:5 row_mask:0xf bank_mask:0xf
    s_waitcnt lgkmcnt(0)
    v_readfirstlane_b32 s64, v62
    s_cmp_gt_u32 s64, 190
    s_nop 2
    s_cbranch_scc1 L_wk190
    s_waitcnt vmcnt(4)
L_wk190:
    s_waitcnt vmcnt(6)
    buffer_load_dwordx4 v[248:251], v2, s[48:51], s59 offen nt
    s_xor_b32 s59, s57, 0x6f000
    v_mov_b32 v6, 190
    ds_write_b32 v7, v6 offset:272
    v_mfma_f32_16x16x32_bf16 v[48:51], v[44:47], v[212:215], v[48:51]
    v_and_b32_dpp v40, v35, v28 row_newbcast:6 row_mask:0xf bank_mask:0xf
    v_and_b32_dpp v41, v35, v29 row_newbcast:6 row_mask:0xf bank_mask:0xf
    v_and_b32_dpp v42, v35, v30 row_newbcast:6 row_mask:0xf bank_mask:0xf
    v_and_b32_dpp v43, v35, v31 row_newbcast:6 row_mask:0xf bank_mask:0xf
    s_cmp_gt_u32 s64, 191
    s_nop 1
    s_cbranch_scc1 L_wk191
    s_waitcnt vmcnt(4)
L_wk191:
    s_waitcnt vmcnt(6)
    buffer_load_dwordx4 v[252:255], v2, s[48:51], s59 offen nt
    s_xor_b32 s59, s57, 0x80000
    ds_read_b32 v62, v7 offset:288
    v_mov_b32 v6, 191
    ds_write_b32 v7, v6 offset:272
    v_mfma_f32_16x16x32_bf16 v[48:51], v[40:43], v[216:219], v[48:51]
    v_and_b32_dpp v44, v35, v28 row_newbcast:7 row_mask:0xf bank_mask:0xf
    v_and_b32_dpp v45, v35, v29 row_newbcast:7 row_mask:0xf bank_mask:0xf
    v_and_b32_dpp v46, v35, v30 row_newbcast:7 row_mask:0xf bank_mask:0xf
    v_and_b32_dpp v47, v35, v31 row_newbcast:7 row_mask:0xf bank_mask:0xf
    s_waitcnt lgkmcnt(0)
    v_readfirstlane_b32 s64, v62
    s_cmp_gt_u32 s64, 192
    s_nop 2
    s_cbranch_scc1 L_wk192
    s_waitcnt vmcnt(4)
L_wk192:
    s_waitcnt vmcnt(6)
    buffer_load_dwordx4 v[64:67], v2, s[48:51], s59 offen nt
    s_xor_b32 s59, s57, 0x82000
    v_mov_b32 v6, 192
    ds_write_b32 v7, v6 offset:272
    v_mfma_f32_16x16x32_bf16 v[48:51], v[44:47], v[220:223], v[48:51]
    v_and_b32_dpp v40, v35, v28 row_newbcast:8 row_mask:0xf bank_mask:0xf
    v_and_b32_dpp v41, v35, v29 row_newbcast:8 row_mask:0xf bank_mask:0xf
    v_and_b32_dpp v42, v35, v30 row_newbcast:8 row_mask:0xf bank_mask:0xf
    v_and_b32_dpp v43, v35, v31 row_newbcast:8 row_mask:0xf bank_mask:0xf
    s_cmp_gt_u32 s64, 193
    s_nop 1
    s_cbranch_scc1 L_wk193
    s_waitcnt vmcnt(4)
L_wk193:
    s_waitcnt vmcnt(6)
    buffer_load_dwordx4 v[68:71], v2, s[48:51], s59 offen nt
    s_xor_b32 s59, s57, 0x81000
    ds_read_b32 v62, v7 offset:288
    v_mov_b32 v6, 193
    ds_write_b32 v7, v6 offset:272
    v_mfma_f32_16x16x32_bf16 v[48:51], v[40:43], v[224:227], v[48:51]
    v_and_b32_dpp v44, v35, v28 row_newbcast:9 row_mask:0xf bank_mask:0xf
    v_and_b32_dpp v45, v35, v29 row_newbcast:9 row_mask:0xf bank_mask:0xf
    v_and_b32_dpp v46, v35, v30 row_newbcast:9 row_mask:0xf bank_mask:0xf
    v_and_b32_dpp v47, v35, v31 row_newbcast:9 row_mask:0xf bank_mask:0xf
    s_waitcnt lgkmcnt(0)
    v_readfirstlane_b32 s64, v62
    s_cmp_gt_u32 s64, 194
    s_nop 2
    s_cbranch_scc1 L_wk194
    s_waitcnt vmcnt(4)
L_wk194:
    s_waitcnt vmcnt(6)
    buffer_load_dwordx4 v[72:75], v2, s[48:51], s59 offen nt
    s_xor_b32 s59, s57, 0x83000
    v_mov_b32 v6, 194
    ds_write_b32 v7, v6 offset:272
    v_mfma_f32_16x16x32_bf16 v[48:51], v[44:47], v[228:231], v[48:51]
    v_and_b32_dpp v40, v35, v28 row_newbcast:10 row_mask:0xf bank_mask:0xf
    v_and_b32_dpp v41, v35, v29 row_newbcast:10 row_mask:0xf bank_mask:0xf
    v_and_b32_dpp v42, v35, v30 row_newbcast:10 row_mask:0xf bank_mask:0xf
    v_and_b32_dpp v43, v35, v31 row_newbcast:10 row_mask:0xf bank_mask:0xf
    s_cmp_gt_u32 s64, 195
    s_nop 1
    s_cbranch_scc1 L_wk195
    s_waitcnt vmcnt(4)
L_wk195:
    s_waitcnt vmcnt(6)
    buffer_load_dwordx4 v[76:79], v2, s[48:51], s59 offen nt
    s_xor_b32 s59, s57, 0x84000
    ds_read_b32 v62, v7 offset:288
    v_mov_b32 v6, 195
    ds_write_b32 v7, v6 offset:272
    v_mfma_f32_16x16x32_bf16 v[48:51], v[40:43], v[232:235], v[48:51]
    v_and_b32_dpp v44, v35, v28 row_newbcast:11 row_mask:0xf bank_mask:0xf
    v_and_b32_dpp v45, v35, v29 row_newbcast:11 row_mask:0xf bank_mask:0xf
    v_and_b32_dpp v46, v35, v30 row_newbcast:11 row_mask:0xf bank_mask:0xf
    v_and_b32_dpp v47, v35, v31 row_newbcast:11 row_mask:0xf bank_mask:0xf
    s_waitcnt lgkmcnt(0)
    v_readfirstlane_b32 s64, v62
    s_cmp_gt_u32 s64, 196
    s_nop 2
    s_cbranch_scc1 L_wk196
    s_waitcnt vmcnt(4)
L_wk196:
    s_waitcnt vmcnt(6)
    buffer_load_dwordx4 v[80:83], v2, s[48:51], s59 offen nt
    s_xor_b32 s59, s57, 0x86000
    v_mov_b32 v6, 196
    ds_write_b32 v7, v6 offset:272
    v_mfma_f32_16x16x32_bf16 v[48:51], v[44:47], v[236:239], v[48:51]
    v_and_b32_dpp v40, v35, v28 row_newbcast:12 row_mask:0xf bank_mask:0xf
    v_and_b32_dpp v41, v35, v29 row_newbcast:12 row_mask:0xf bank_mask:0xf
    v_and_b32_dpp v42, v35, v30 row_newbcast:12 row_mask:0xf bank_mask:0xf
    v_and_b32_dpp v43, v35, v31 row_newbcast:12 row_mask:0xf bank_mask:0xf
    s_cmp_gt_u32 s64, 197
    s_nop 1
    s_cbranch_scc1 L_wk197
    s_waitcnt vmcnt(4)
L_wk197:
    s_waitcnt vmcnt(6)
    buffer_load_dwordx4 v[84:87], v2, s[48:51], s59 offen nt
    s_xor_b32 s59, s57, 0x85000
    ds_read_b32 v62, v7 offset:288
    v_mov_b32 v6, 197
    ds_write_b32 v7, v6 offset:272
    v_mfma_f32_16x16x32_bf16 v[48:51], v[40:43], v[240:243], v[48:51]
    v_and_b32_dpp v44, v35, v28 row_newbcast:13 row_mask:0xf bank_mask:0xf
    v_and_b32_dpp v45, v35, v29 row_newbcast:13 row_mask:0xf bank_mask:0xf
    v_and_b32_dpp v46, v35, v30 row_newbcast:13 row_mask:0xf bank_mask:0xf
    v_and_b32_dpp v47, v35, v31 row_newbcast:13 row_mask:0xf bank_mask:0xf
    s_waitcnt lgkmcnt(0)
    v_readfirstlane_b32 s64, v62
    s_cmp_gt_u32 s64, 198
    s_nop 2
    s_cbranch_scc1 L_wk198
    s_waitcnt vmcnt(4)
L_wk198:
    s_waitcnt vmcnt(6)
    buffer_load_dwordx4 v[88:91], v2, s[48:51], s59 offen nt
    s_xor_b32 s59, s57, 0x87000
    v_mov_b32 v6, 198
    ds_write_b32 v7, v6 offset:272
    v_mfma_f32_16x16x32_bf16 v[48:51], v[44:47], v[244:247], v[48:51]
    v_and_b32_dpp v40, v35, v28 row_newbcast:14 row_mask:0xf bank_mask:0xf
    v_and_b32_dpp v41, v35, v29 row_newbcast:14 row_mask:0xf bank_mask:0xf
    v_and_b32_dpp v42, v35, v30 row_newbcast:14 row_mask:0xf bank_mask:0xf
    v_and_b32_dpp v43, v35, v31 row_newbcast:14 row_mask:0xf bank_mask:0xf
    s_cmp_gt_u32 s64, 199
    s_nop 1
    s_cbranch_scc1 L_wk199
    s_waitcnt vmcnt(4)
L_wk199:
    s_waitcnt vmcnt(6)
    buffer_load_dwordx4 v[92:95], v2, s[48:51], s59 offen nt
    s_xor_b32 s59, s57, 0x88000
    ds_read_b32 v62, v7 offset:288
    v_mov_b32 v6, 199
    ds_write_b32 v7, v6 offset:272
    v_mfma_f32_16x16x32_bf16 v[48:51], v[40:43], v[248:251], v[48:51]
    v_and_b32_dpp v44, v35, v28 row_newbcast:15 row_mask:0xf bank_mask:0xf
    v_and_b32_dpp v45, v35, v29 row_newbcast:15 row_mask:0xf bank_mask:0xf
    v_and_b32_dpp v46, v35, v30 row_newbcast:15 row_mask:0xf bank_mask:0xf
    v_and_b32_dpp v47, v35, v31 row_newbcast:15 row_mask:0xf bank_mask:0xf
    s_waitcnt lgkmcnt(0)
    v_readfirstlane_b32 s64, v62
    s_cmp_gt_u32 s64, 200
    s_nop 2
    s_cbranch_scc1 L_wk200
    s_waitcnt vmcnt(4)
L_wk200:
    s_waitcnt vmcnt(6)
    buffer_load_dwordx4 v[96:99], v2, s[48:51], s59 offen nt
    s_xor_b32 s59, s57, 0x8a000
    v_mov_b32 v6, 200
    ds_write_b32 v7, v6 offset:272
    v_mfma_f32_16x16x32_bf16 v[48:51], v[44:47], v[252:255], v[48:51]
    v_and_b32_dpp v40, v36, v28 row_newbcast:0 row_mask:0xf bank_mask:0xf
    v_and_b32_dpp v41, v36, v29 row_newbcast:0 row_mask:0xf bank_mask:0xf
    v_and_b32_dpp v42, v36, v30 row_newbcast:0 row_mask:0xf bank_mask:0xf
    v_and_b32_dpp v43, v36, v31 row_newbcast:0 row_mask:0xf bank_mask:0xf
    s_cmp_gt_u32 s64, 201
    s_nop 1
    s_cbranch_scc1 L_wk201
    s_waitcnt vmcnt(4)
L_wk201:
    s_waitcnt vmcnt(6)
    buffer_load_dwordx4 v[100:103], v2, s[48:51], s59 offen nt
    s_xor_b32 s59, s57, 0x89000
    ds_read_b32 v62, v7 offset:288
    v_mov_b32 v6, 201
    ds_write_b32 v7, v6 offset:272
    v_mfma_f32_16x16x32_bf16 v[48:51], v[40:43], v[64:67], v[48:51]
    v_and_b32_dpp v44, v36, v28 row_newbcast:1 row_mask:0xf bank_mask:0xf
    v_and_b32_dpp v45, v36, v29 row_newbcast:1 row_mask:0xf bank_mask:0xf
    v_and_b32_dpp v46, v36, v30 row_newbcast:1 row_mask:0xf bank_mask:0xf
    v_and_b32_dpp v47, v36, v31 row_newbcast:1 row_mask:0xf bank_mask:0xf
    s_waitcnt lgkmcnt(0)
    v_readfirstlane_b32 s64, v62
    s_cmp_gt_u32 s64, 202
    s_nop 2
    s_cbranch_scc1 L_wk202
    s_waitcnt vmcnt(4)
L_wk202:
    s_waitcnt vmcnt(6)
    buffer_load_dwordx4 v[104:107], v2, s[48:51], s59 offen nt
    s_xor_b32 s59, s57, 0x8b000
    v_mov_b32 v6, 202
    ds_write_b32 v7, v6 offset:272
    v_mfma_f32_16x16x32_bf16 v[48:51], v[44:47], v[68:71], v[48:51]
    v_and_b32_dpp v40, v36, v28 row_newbcast:2 row_mask:0xf bank_mask:0xf
    v_and_b32_dpp v41, v36, v29 row_newbcast:2 row_mask:0xf bank_mask:0xf
    v_and_b32_dpp v42, v36, v30 row_newbcast:2 row_mask:0xf bank_mask:0xf
    v_and_b32_dpp v43, v36, v31 row_newbcast:2 row_mask:0xf bank_mask:0xf
    s_cmp_gt_u32 s64, 203
    s_nop 1
    s_cbranch_scc1 L_wk203
    s_waitcnt vmcnt(4)
L_wk203:
    s_waitcnt vmcnt(6)
    buffer_load_dwordx4 v[108:111], v2, s[48:51], s59 offen nt
    s_xor_b32 s59, s57, 0x8c000
    ds_read_b32 v62, v7 offset:288
    v_mov_b32 v6, 203
    ds_write_b32 v7, v6 offset:272
    v_mfma_f32_16x16x32_bf16 v[48:51], v[40:43], v[72:75], v[48:51]
    v_and_b32_dpp v44, v36, v28 row_newbcast:3 row_mask:0xf bank_mask:0xf
    v_and_b32_dpp v45, v36, v29 row_newbcast:3 row_mask:0xf bank_mask:0xf
    v_and_b32_dpp v46, v36, v30 row_newbcast:3 row_mask:0xf bank_mask:0xf
    v_and_b32_dpp v47, v36, v31 row_newbcast:3 row_mask:0xf bank_mask:0xf
    s_waitcnt lgkmcnt(0)
    v_readfirstlane_b32 s64, v62
    s_cmp_gt_u32 s64, 204
    s_nop 2
    s_cbranch_scc1 L_wk204
    s_waitcnt vmcnt(4)
L_wk204:
    s_waitcnt vmcnt(6)
    buffer_load_dwordx4 v[112:115], v2, s[48:51], s59 offen nt
    s_xor_b32 s59, s57, 0x8e000
    v_mov_b32 v6, 204
    ds_write_b32 v7, v6 offset:272
    v_mfma_f32_16x16x32_bf16 v[48:51], v[44:47], v[76:79], v[48:51]
    v_and_b32_dpp v40, v36, v28 row_newbcast:4 row_mask:0xf bank_mask:0xf
    v_and_b32_dpp v41, v36, v29 row_newbcast:4 row_mask:0xf bank_mask:0xf
    v_and_b32_dpp v42, v36, v30 row_newbcast:4 row_mask:0xf bank_mask:0xf
    v_and_b32_dpp v43, v36, v31 row_newbcast:4 row_mask:0xf bank_mask:0xf
    s_cmp_gt_u32 s64, 205
    s_nop 1
    s_cbranch_scc1 L_wk205
    s_waitcnt vmcnt(4)
L_wk205:
    s_waitcnt vmcnt(6)
    buffer_load_dwordx4 v[116:119], v2, s[48:51], s59 offen nt
    s_xor_b32 s59, s57, 0x8d000
    ds_read_b32 v62, v7 offset:288
    v_mov_b32 v6, 205
    ds_write_b32 v7, v6 offset:272
    v_mfma_f32_16x16x32_bf16 v[48:51], v[40:43], v[80:83], v[48:51]
    v_and_b32_dpp v44, v36, v28 row_newbcast:5 row_mask:0xf bank_mask:0xf
    v_and_b32_dpp v45, v36, v29 row_newbcast:5 row_mask:0xf bank_mask:0xf
    v_and_b32_dpp v46, v36, v30 row_newbcast:5 row_mask:0xf bank_mask:0xf
    v_and_b32_dpp v47, v36, v31 row_newbcast:5 row_mask:0xf bank_mask:0xf
    s_waitcnt lgkmcnt(0)
    v_readfirstlane_b32 s64, v62
    s_cmp_gt_u32 s64, 206
    s_nop 2
    s_cbranch_scc1 L_wk206
    s_waitcnt vmcnt(4)
L_wk206:
    s_waitcnt vmcnt(6)
    buffer_load_dwordx4 v[120:123], v2, s[48:51], s59 offen nt
    s_xor_b32 s59, s57, 0x8f000
    v_mov_b32 v6, 206
    ds_write_b32 v7, v6 offset:272
    v_mfma_f32_16x16x32_bf16 v[48:51], v[44:47], v[84:87], v[48:51]
    v_and_b32_dpp v40, v36, v28 row_newbcast:6 row_mask:0xf bank_mask:0xf
    v_and_b32_dpp v41, v36, v29 row_newbcast:6 row_mask:0xf bank_mask:0xf
    v_and_b32_dpp v42, v36, v30 row_newbcast:6 row_mask:0xf bank_mask:0xf
    v_and_b32_dpp v43, v36, v31 row_newbcast:6 row_mask:0xf bank_mask:0xf
    s_cmp_gt_u32 s64, 207
    s_nop 1
    s_cbranch_scc1 L_wk207
    s_waitcnt vmcnt(4)
L_wk207:
    s_waitcnt vmcnt(6)
    buffer_load_dwordx4 v[124:127], v2, s[48:51], s59 offen nt
    s_xor_b32 s59, s57, 0xc0000
    ds_read_b32 v62, v7 offset:288
    v_mov_b32 v6, 207
    ds_write_b32 v7, v6 offset:272
    v_mfma_f32_16x16x32_bf16 v[48:51], v[40:43], v[88:91], v[48:51]
    v_and_b32_dpp v44, v36, v28 row_newbcast:7 row_mask:0xf bank_mask:0xf
    v_and_b32_dpp v45, v36, v29 row_newbcast:7 row_mask:0xf bank_mask:0xf
    v_and_b32_dpp v46, v36, v30 row_newbcast:7 row_mask:0xf bank_mask:0xf
    v_and_b32_dpp v47, v36, v31 row_newbcast:7 row_mask:0xf bank_mask:0xf
    s_waitcnt lgkmcnt(0)
    v_readfirstlane_b32 s64, v62
    s_cmp_gt_u32 s64, 208
    s_nop 2
    s_cbranch_scc1 L_wk208
    s_waitcnt vmcnt(4)
L_wk208:
    s_waitcnt vmcnt(6)
    buffer_load_dwordx4 v[128:131], v2, s[48:51], s59 offen nt
    s_xor_b32 s59, s57, 0xc2000
    v_mov_b32 v6, 208
    ds_write_b32 v7, v6 offset:272
    v_mfma_f32_16x16x32_bf16 v[48:51], v[44:47], v[92:95], v[48:51]
    v_and_b32_dpp v40, v36, v28 row_newbcast:8 row_mask:0xf bank_mask:0xf
    v_and_b32_dpp v41, v36, v29 row_newbcast:8 row_mask:0xf bank_mask:0xf
    v_and_b32_dpp v42, v36, v30 row_newbcast:8 row_mask:0xf bank_mask:0xf
    v_and_b32_dpp v43, v36, v31 row_newbcast:8 row_mask:0xf bank_mask:0xf
    s_cmp_gt_u32 s64, 209
    s_nop 1
    s_cbranch_scc1 L_wk209
    s_waitcnt vmcnt(4)
L_wk209:
    s_waitcnt vmcnt(6)
    buffer_load_dwordx4 v[132:135], v2, s[48:51], s59 offen nt
    s_xor_b32 s59, s57, 0xc1000
    ds_read_b32 v62, v7 offset:288
    v_mov_b32 v6, 209
    ds_write_b32 v7, v6 offset:272
    v_mfma_f32_16x16x32_bf16 v[48:51], v[40:43], v[96:99], v[48:51]
    v_and_b32_dpp v44, v36, v28 row_newbcast:9 row_mask:0xf bank_mask:0xf
    v_and_b32_dpp v45, v36, v29 row_newbcast:9 row_mask:0xf bank_mask:0xf
    v_and_b32_dpp v46, v36, v30 row_newbcast:9 row_mask:0xf bank_mask:0xf
    v_and_b32_dpp v47, v36, v31 row_newbcast:9 row_mask:0xf bank_mask:0xf
    s_waitcnt lgkmcnt(0)
    v_readfirstlane_b32 s64, v62
    s_cmp_gt_u32 s64, 210
    s_nop 2
    s_cbranch_scc1 L_wk210
    s_waitcnt vmcnt(4)
L_wk210:
    s_waitcnt vmcnt(6)
    buffer_load_dwordx4 v[136:139], v2, s[48:51], s59 offen nt
    s_xor_b32 s59, s57, 0xc3000
    v_mov_b32 v6, 210
    ds_write_b32 v7, v6 offset:272
    v_mfma_f32_16x16x32_bf16 v[48:51], v[44:47], v[100:103], v[48:51]
    v_and_b32_dpp v40, v36, v28 row_newbcast:10 row_mask:0xf bank_mask:0xf
    v_and_b32_dpp v41, v36, v29 row_newbcast:10 row_mask:0xf bank_mask:0xf
    v_and_b32_dpp v42, v36, v30 row_newbcast:10 row_mask:0xf bank_mask:0xf
    v_and_b32_dpp v43, v36, v31 row_newbcast:10 row_mask:0xf bank_mask:0xf
    s_cmp_gt_u32 s64, 211
    s_nop 1
    s_cbranch_scc1 L_wk211
    s_waitcnt vmcnt(4)
L_wk211:
    s_waitcnt vmcnt(6)
    buffer_load_dwordx4 v[140:143], v2, s[48:51], s59 offen nt
    s_xor_b32 s59, s57, 0xc4000
    ds_read_b32 v62, v7 offset:288
    v_mov_b32 v6, 211
    ds_write_b32 v7, v6 offset:272
    v_mfma_f32_16x16x32_bf16 v[48:51], v[40:43], v[104:107], v[48:51]
    v_and_b32_dpp v44, v36, v28 row_newbcast:11 row_mask:0xf bank_mask:0xf
    v_and_b32_dpp v45, v36, v29 row_newbcast:11 row_mask:0xf bank_mask:0xf
    v_and_b32_dpp v46, v36, v30 row_newbcast:11 row_mask:0xf bank_mask:0xf
    v_and_b32_dpp v47, v36, v31 row_newbcast:11 row_mask:0xf bank_mask:0xf
    s_waitcnt lgkmcnt(0)
    v_readfirstlane_b32 s64, v62
    s_cmp_gt_u32 s64, 212
    s_nop 2
    s_cbranch_scc1 L_wk212
    s_waitcnt vmcnt(4)
L_wk212:
    s_waitcnt vmcnt(6)
    buffer_load_dwordx4 v[144:147], v2, s[48:51], s59 offen nt
    s_xor_b32 s59, s57, 0xc6000
    v_mov_b32 v6, 212
    ds_write_b32 v7, v6 offset:272
    v_mfma_f32_16x16x32_bf16 v[48:51], v[44:47], v[108:111], v[48:51]
    v_and_b32_dpp v40, v36, v28 row_newbcast:12 row_mask:0xf bank_mask:0xf
    v_and_b32_dpp v41, v36, v29 row_newbcast:12 row_mask:0xf bank_mask:0xf
    v_and_b32_dpp v42, v36, v30 row_newbcast:12 row_mask:0xf bank_mask:0xf
    v_and_b32_dpp v43, v36, v31 row_newbcast:12 row_mask:0xf bank_mask:0xf
    s_cmp_gt_u32 s64, 213
    s_nop 1
    s_cbranch_scc1 L_wk213
    s_waitcnt vmcnt(4)
L_wk213:
    s_waitcnt vmcnt(6)
    buffer_load_dwordx4 v[148:151], v2, s[48:51], s59 offen nt
    s_xor_b32 s59, s57, 0xc5000
    ds_read_b32 v62, v7 offset:288
    v_mov_b32 v6, 213
    ds_write_b32 v7, v6 offset:272
    v_mfma_f32_16x16x32_bf16 v[48:51], v[40:43], v[112:115], v[48:51]
    v_and_b32_dpp v44, v36, v28 row_newbcast:13 row_mask:0xf bank_mask:0xf
    v_and_b32_dpp v45, v36, v29 row_newbcast:13 row_mask:0xf bank_mask:0xf
    v_and_b32_dpp v46, v36, v30 row_newbcast:13 row_mask:0xf bank_mask:0xf
    v_and_b32_dpp v47, v36, v31 row_newbcast:13 row_mask:0xf bank_mask:0xf
    s_waitcnt lgkmcnt(0)
    v_readfirstlane_b32 s64, v62
    s_cmp_gt_u32 s64, 214
    s_nop 2
    s_cbranch_scc1 L_wk214
    s_waitcnt vmcnt(4)
L_wk214:
    s_waitcnt vmcnt(6)
    buffer_load_dwordx4 v[152:155], v2, s[48:51], s59 offen nt
    s_xor_b32 s59, s57, 0xc7000
    v_mov_b32 v6, 214
    ds_write_b32 v7, v6 offset:272
    v_mfma_f32_16x16x32_bf16 v[48:51], v[44:47], v[116:119], v[48:51]
    v_and_b32_dpp v40, v36, v28 row_newbcast:14 row_mask:0xf bank_mask:0xf
    v_and_b32_dpp v41, v36, v29 row_newbcast:14 row_mask:0xf bank_mask:0xf
    v_and_b32_dpp v42, v36, v30 row_newbcast:14 row_mask:0xf bank_mask:0xf
    v_and_b32_dpp v43, v36, v31 row_newbcast:14 row_mask:0xf bank_mask:0xf
    s_cmp_gt_u32 s64, 215
    s_nop 1
    s_cbranch_scc1 L_wk215
    s_waitcnt vmcnt(4)
L_wk215:
    s_waitcnt vmcnt(6)
    buffer_load_dwordx4 v[156:159], v2, s[48:51], s59 offen nt
    s_xor_b32 s59, s57, 0xc8000
    ds_read_b32 v62, v7 offset:288
    v_mov_b32 v6, 215
    ds_write_b32 v7, v6 offset:272
    v_mfma_f32_16x16x32_bf16 v[48:51], v[40:43], v[120:123], v[48:51]
    v_and_b32_dpp v44, v36, v28 row_newbcast:15 row_mask:0xf bank_mask:0xf
    v_and_b32_dpp v45, v36, v29 row_newbcast:15 row_mask:0xf bank_mask:0xf
    v_and_b32_dpp v46, v36, v30 row_newbcast:15 row_mask:0xf bank_mask:0xf
    v_and_b32_dpp v47, v36, v31 row_newbcast:15 row_mask:0xf bank_mask:0xf
    s_waitcnt lgkmcnt(0)
    v_readfirstlane_b32 s64, v62
    s_cmp_gt_u32 s64, 216
    s_nop 2
    s_cbranch_scc1 L_wk216
    s_waitcnt vmcnt(4)
L_wk216:
    s_waitcnt vmcnt(6)
    buffer_load_dwordx4 v[160:163], v2, s[48:51], s59 offen nt
    s_xor_b32 s59, s57, 0xca000
    v_mov_b32 v6, 216
    ds_write_b32 v7, v6 offset:272
    v_mfma_f32_16x16x32_bf16 v[48:51], v[44:47], v[124:127], v[48:51]
    v_and_b32_dpp v40, v37, v28 row_newbcast:0 row_mask:0xf bank_mask:0xf
    v_and_b32_dpp v41, v37, v29 row_newbcast:0 row_mask:0xf bank_mask:0xf
    v_and_b32_dpp v42, v37, v30 row_newbcast:0 row_mask:0xf bank_mask:0xf
    v_and_b32_dpp v43, v37, v31 row_newbcast:0 row_mask:0xf bank_mask:0xf
    s_cmp_gt_u32 s64, 217
    s_nop 1
    s_cbranch_scc1 L_wk217
    s_waitcnt vmcnt(4)
L_wk217:
    s_waitcnt vmcnt(6)
    buffer_load_dwordx4 v[164:167], v2, s[48:51], s59 offen nt
    s_xor_b32 s59, s57, 0xc9000
    ds_read_b32 v62, v7 offset:288
    v_mov_b32 v6, 217
    ds_write_b32 v7, v6 offset:272
    v_mfma_f32_16x16x32_bf16 v[48:51], v[40:43], v[128:131], v[48:51]
    v_and_b32_dpp v44, v37, v28 row_newbcast:1 row_mask:0xf bank_mask:0xf
    v_and_b32_dpp v45, v37, v29 row_newbcast:1 row_mask:0xf bank_mask:0xf
    v_and_b32_dpp v46, v37, v30 row_newbcast:1 row_mask:0xf bank_mask:0xf
    v_and_b32_dpp v47, v37, v31 row_newbcast:1 row_mask:0xf bank_mask:0xf
    s_waitcnt lgkmcnt(0)
    v_readfirstlane_b32 s64, v62
    s_cmp_gt_u32 s64, 218
    s_nop 2
    s_cbranch_scc1 L_wk218
    s_waitcnt vmcnt(4)
L_wk218:
    s_waitcnt vmcnt(6)
    buffer_load_dwordx4 v[168:171], v2, s[48:51], s59 offen nt
    s_xor_b32 s59, s57, 0xcb000
    v_mov_b32 v6, 218
    ds_write_b32 v7, v6 offset:272
    v_mfma_f32_16x16x32_bf16 v[48:51], v[44:47], v[132:135], v[48:51]
    v_and_b32_dpp v40, v37, v28 row_newbcast:2 row_mask:0xf bank_mask:0xf
    v_and_b32_dpp v41, v37, v29 row_newbcast:2 row_mask:0xf bank_mask:0xf
    v_and_b32_dpp v42, v37, v30 row_newbcast:2 row_mask:0xf bank_mask:0xf
    v_and_b32_dpp v43, v37, v31 row_newbcast:2 row_mask:0xf bank_mask:0xf
    s_cmp_gt_u32 s64, 219
    s_nop 1
    s_cbranch_scc1 L_wk219
    s_waitcnt vmcnt(4)
L_wk219:
    s_waitcnt vmcnt(6)
    buffer_load_dwordx4 v[172:175], v2, s[48:51], s59 offen nt
    s_xor_b32 s59, s57, 0xcc000
    ds_read_b32 v62, v7 offset:288
    v_mov_b32 v6, 219
    ds_write_b32 v7, v6 offset:272
    v_mfma_f32_16x16x32_bf16 v[48:51], v[40:43], v[136:139], v[48:51]
    v_and_b32_dpp v44, v37, v28 row_newbcast:3 row_mask:0xf bank_mask:0xf
    v_and_b32_dpp v45, v37, v29 row_newbcast:3 row_mask:0xf bank_mask:0xf
    v_and_b32_dpp v46, v37, v30 row_newbcast:3 row_mask:0xf bank_mask:0xf
    v_and_b32_dpp v47, v37, v31 row_newbcast:3 row_mask:0xf bank_mask:0xf
    s_waitcnt lgkmcnt(0)
    v_readfirstlane_b32 s64, v62
    s_cmp_gt_u32 s64, 220
    s_nop 2
    s_cbranch_scc1 L_wk220
    s_waitcnt vmcnt(4)
L_wk220:
    s_waitcnt vmcnt(6)
    buffer_load_dwordx4 v[176:179], v2, s[48:51], s59 offen nt
    s_xor_b32 s59, s57, 0xce000
    v_mov_b32 v6, 220
    ds_write_b32 v7, v6 offset:272
    v_mfma_f32_16x16x32_bf16 v[48:51], v[44:47], v[140:143], v[48:51]
    v_and_b32_dpp v40, v37, v28 row_newbcast:4 row_mask:0xf bank_mask:0xf
    v_and_b32_dpp v41, v37, v29 row_newbcast:4 row_mask:0xf bank_mask:0xf
    v_and_b32_dpp v42, v37, v30 row_newbcast:4 row_mask:0xf bank_mask:0xf
    v_and_b32_dpp v43, v37, v31 row_newbcast:4 row_mask:0xf bank_mask:0xf
    s_cmp_gt_u32 s64, 221
    s_nop 1
    s_cbranch_scc1 L_wk221
    s_waitcnt vmcnt(4)
L_wk221:
    s_waitcnt vmcnt(6)
    buffer_load_dwordx4 v[180:183], v2, s[48:51], s59 offen nt
    s_xor_b32 s59, s57, 0xcd000
    ds_read_b32 v62, v7 offset:288
    v_mov_b32 v6, 221
    ds_write_b32 v7, v6 offset:272
    v_mfma_f32_16x16x32_bf16 v[48:51], v[40:43], v[144:147], v[48:51]
    v_and_b32_dpp v44, v37, v28 row_newbcast:5 row_mask:0xf bank_mask:0xf
    v_and_b32_dpp v45, v37, v29 row_newbcast:5 row_mask:0xf bank_mask:0xf
    v_and_b32_dpp v46, v37, v30 row_newbcast:5 row_mask:0xf bank_mask:0xf
    v_and_b32_dpp v47, v37, v31 row_newbcast:5 row_mask:0xf bank_mask:0xf
    s_waitcnt lgkmcnt(0)
    v_readfirstlane_b32 s64, v62
    s_cmp_gt_u32 s64, 222
    s_nop 2
    s_cbranch_scc1 L_wk222
    s_waitcnt vmcnt(4)
L_wk222:
    s_waitcnt vmcnt(6)
    buffer_load_dwordx4 v[184:187], v2, s[48:51], s59 offen nt
    s_xor_b32 s59, s57, 0xcf000
    v_mov_b32 v6, 222
    ds_write_b32 v7, v6 offset:272
    v_mfma_f32_16x16x32_bf16 v[48:51], v[44:47], v[148:151], v[48:51]
    v_and_b32_dpp v40, v37, v28 row_newbcast:6 row_mask:0xf bank_mask:0xf
    v_and_b32_dpp v41, v37, v29 row_newbcast:6 row_mask:0xf bank_mask:0xf
    v_and_b32_dpp v42, v37, v30 row_newbcast:6 row_mask:0xf bank_mask:0xf
    v_and_b32_dpp v43, v37, v31 row_newbcast:6 row_mask:0xf bank_mask:0xf
    s_cmp_gt_u32 s64, 223
    s_nop 1
    s_cbranch_scc1 L_wk223
    s_waitcnt vmcnt(4)
L_wk223:
    s_waitcnt vmcnt(6)
    buffer_load_dwordx4 v[188:191], v2, s[48:51], s59 offen nt
    s_xor_b32 s59, s57, 0xa0000
    ds_read_b32 v62, v7 offset:288
    v_mov_b32 v6, 223
    ds_write_b32 v7, v6 offset:272
    v_mfma_f32_16x16x32_bf16 v[48:51], v[40:43], v[152:155], v[48:51]
    v_and_b32_dpp v44, v37, v28 row_newbcast:7 row_mask:0xf bank_mask:0xf
    v_and_b32_dpp v45, v37, v29 row_newbcast:7 row_mask:0xf bank_mask:0xf
    v_and_b32_dpp v46, v37, v30 row_newbcast:7 row_mask:0xf bank_mask:0xf
    v_and_b32_dpp v47, v37, v31 row_newbcast:7 row_mask:0xf bank_mask:0xf
    s_waitcnt lgkmcnt(0)
    v_readfirstlane_b32 s64, v62
    s_cmp_gt_u32 s64, 224
    s_nop 2
    s_cbranch_scc1 L_wk224
    s_waitcnt vmcnt(4)
L_wk224:
    s_waitcnt vmcnt(6)
    buffer_load_dwordx4 v[192:195], v2, s[48:51], s59 offen nt
    s_xor_b32 s59, s57, 0xa2000
    v_mov_b32 v6, 224
    ds_write_b32 v7, v6 offset:272
    v_mfma_f32_16x16x32_bf16 v[48:51], v[44:47], v[156:159], v[48:51]
    v_and_b32_dpp v40, v37, v28 row_newbcast:8 row_mask:0xf bank_mask:0xf
    v_and_b32_dpp v41, v37, v29 row_newbcast:8 row_mask:0xf bank_mask:0xf
    v_and_b32_dpp v42, v37, v30 row_newbcast:8 row_mask:0xf bank_mask:0xf
    v_and_b32_dpp v43, v37, v31 row_newbcast:8 row_mask:0xf bank_mask:0xf
    s_cmp_gt_u32 s64, 225
    s_nop 1
    s_cbranch_scc1 L_wk225
    s_waitcnt vmcnt(4)
L_wk225:
    s_waitcnt vmcnt(6)
    buffer_load_dwordx4 v[196:199], v2, s[48:51], s59 offen nt
    s_xor_b32 s59, s57, 0xa1000
    ds_read_b32 v62, v7 offset:288
    v_mov_b32 v6, 225
    ds_write_b32 v7, v6 offset:272
    v_mfma_f32_16x16x32_bf16 v[48:51], v[40:43], v[160:163], v[48:51]
    v_and_b32_dpp v44, v37, v28 row_newbcast:9 row_mask:0xf bank_mask:0xf
    v_and_b32_dpp v45, v37, v29 row_newbcast:9 row_mask:0xf bank_mask:0xf
    v_and_b32_dpp v46, v37, v30 row_newbcast:9 row_mask:0xf bank_mask:0xf
    v_and_b32_dpp v47, v37, v31 row_newbcast:9 row_mask:0xf bank_mask:0xf
    s_waitcnt lgkmcnt(0)
    v_readfirstlane_b32 s64, v62
    s_cmp_gt_u32 s64, 226
    s_nop 2
    s_cbranch_scc1 L_wk226
    s_waitcnt vmcnt(4)
L_wk226:
    s_waitcnt vmcnt(6)
    buffer_load_dwordx4 v[200:203], v2, s[48:51], s59 offen nt
    s_xor_b32 s59, s57, 0xa3000
    v_mov_b32 v6, 226
    ds_write_b32 v7, v6 offset:272
    v_mfma_f32_16x16x32_bf16 v[48:51], v[44:47], v[164:167], v[48:51]
    v_and_b32_dpp v40, v37, v28 row_newbcast:10 row_mask:0xf bank_mask:0xf
    v_and_b32_dpp v41, v37, v29 row_newbcast:10 row_mask:0xf bank_mask:0xf
    v_and_b32_dpp v42, v37, v30 row_newbcast:10 row_mask:0xf bank_mask:0xf
    v_and_b32_dpp v43, v37, v31 row_newbcast:10 row_mask:0xf bank_mask:0xf
    s_cmp_gt_u32 s64, 227
    s_nop 1
    s_cbranch_scc1 L_wk227
    s_waitcnt vmcnt(4)
L_wk227:
    s_waitcnt vmcnt(6)
    buffer_load_dwordx4 v[204:207], v2, s[48:51], s59 offen nt
    s_xor_b32 s59, s57, 0xa4000
    ds_read_b32 v62, v7 offset:288
    v_mov_b32 v6, 227
    ds_write_b32 v7, v6 offset:272
    v_mfma_f32_16x16x32_bf16 v[48:51], v[40:43], v[168:171], v[48:51]
    v_and_b32_dpp v44, v37, v28 row_newbcast:11 row_mask:0xf bank_mask:0xf
    v_and_b32_dpp v45, v37, v29 row_newbcast:11 row_mask:0xf bank_mask:0xf
    v_and_b32_dpp v46, v37, v30 row_newbcast:11 row_mask:0xf bank_mask:0xf
    v_and_b32_dpp v47, v37, v31 row_newbcast:11 row_mask:0xf bank_mask:0xf
    s_waitcnt lgkmcnt(0)
    v_readfirstlane_b32 s64, v62
    s_cmp_gt_u32 s64, 228
    s_nop 2
    s_cbranch_scc1 L_wk228
    s_waitcnt vmcnt(4)
L_wk228:
    s_waitcnt vmcnt(6)
    buffer_load_dwordx4 v[208:211], v2, s[48:51], s59 offen nt
    s_xor_b32 s59, s57, 0xa6000
    v_mov_b32 v6, 228
    ds_write_b32 v7, v6 offset:272
    v_mfma_f32_16x16x32_bf16 v[48:51], v[44:47], v[172:175], v[48:51]
    v_and_b32_dpp v40, v37, v28 row_newbcast:12 row_mask:0xf bank_mask:0xf
    v_and_b32_dpp v41, v37, v29 row_newbcast:12 row_mask:0xf bank_mask:0xf
    v_and_b32_dpp v42, v37, v30 row_newbcast:12 row_mask:0xf bank_mask:0xf
    v_and_b32_dpp v43, v37, v31 row_newbcast:12 row_mask:0xf bank_mask:0xf
    s_cmp_gt_u32 s64, 229
    s_nop 1
    s_cbranch_scc1 L_wk229
    s_waitcnt vmcnt(4)
L_wk229:
    s_waitcnt vmcnt(6)
    buffer_load_dwordx4 v[212:215], v2, s[48:51], s59 offen nt
    s_xor_b32 s59, s57, 0xa5000
    ds_read_b32 v62, v7 offset:288
    v_mov_b32 v6, 229
    ds_write_b32 v7, v6 offset:272
    v_mfma_f32_16x16x32_bf16 v[48:51], v[40:43], v[176:179], v[48:51]
    v_and_b32_dpp v44, v37, v28 row_newbcast:13 row_mask:0xf bank_mask:0xf
    v_and_b32_dpp v45, v37, v29 row_newbcast:13 row_mask:0xf bank_mask:0xf
    v_and_b32_dpp v46, v37, v30 row_newbcast:13 row_mask:0xf bank_mask:0xf
    v_and_b32_dpp v47, v37, v31 row_newbcast:13 row_mask:0xf bank_mask:0xf
    s_waitcnt lgkmcnt(0)
    v_readfirstlane_b32 s64, v62
    s_cmp_gt_u32 s64, 230
    s_nop 2
    s_cbranch_scc1 L_wk230
    s_waitcnt vmcnt(4)
L_wk230:
    s_waitcnt vmcnt(6)
    buffer_load_dwordx4 v[216:219], v2, s[48:51], s59 offen nt
    s_xor_b32 s59, s57, 0xa7000
    v_mov_b32 v6, 230
    ds_write_b32 v7, v6 offset:272
    v_mfma_f32_16x16x32_bf16 v[48:51], v[44:47], v[180:183], v[48:51]
    v_and_b32_dpp v40, v37, v28 row_newbcast:14 row_mask:0xf bank_mask:0xf
    v_and_b32_dpp v41, v37, v29 row_newbcast:14 row_mask:0xf bank_mask:0xf
    v_and_b32_dpp v42, v37, v30 row_newbcast:14 row_mask:0xf bank_mask:0xf
    v_and_b32_dpp v43, v37, v31 row_newbcast:14 row_mask:0xf bank_mask:0xf
    s_cmp_gt_u32 s64, 231
    s_nop 1
    s_cbranch_scc1 L_wk231
    s_waitcnt vmcnt(4)
L_wk231:
    s_waitcnt vmcnt(6)
    buffer_load_dwordx4 v[220:223], v2, s[48:51], s59 offen nt
    s_xor_b32 s59, s57, 0xa8000
    ds_read_b32 v62, v7 offset:288
    v_mov_b32 v6, 231
    ds_write_b32 v7, v6 offset:272
    v_mfma_f32_16x16x32_bf16 v[48:51], v[40:43], v[184:187], v[48:51]
    v_and_b32_dpp v44, v37, v28 row_newbcast:15 row_mask:0xf bank_mask:0xf
    v_and_b32_dpp v45, v37, v29 row_newbcast:15 row_mask:0xf bank_mask:0xf
    v_and_b32_dpp v46, v37, v30 row_newbcast:15 row_mask:0xf bank_mask:0xf
    v_and_b32_dpp v47, v37, v31 row_newbcast:15 row_mask:0xf bank_mask:0xf
    s_waitcnt lgkmcnt(0)
    v_readfirstlane_b32 s64, v62
    s_cmp_gt_u32 s64, 232
    s_nop 2
    s_cbranch_scc1 L_wk232
    s_waitcnt vmcnt(4)
L_wk232:
    s_waitcnt vmcnt(6)
    buffer_load_dwordx4 v[224:227], v2, s[48:51], s59 offen nt
    s_xor_b32 s59, s57, 0xaa000
    v_mov_b32 v6, 232
    ds_write_b32 v7, v6 offset:272
    v_mfma_f32_16x16x32_bf16 v[48:51], v[44:47], v[188:191], v[48:51]
    v_and_b32_dpp v40, v38, v28 row_newbcast:0 row_mask:0xf bank_mask:0xf
    v_and_b32_dpp v41, v38, v29 row_newbcast:0 row_mask:0xf bank_mask:0xf
    v_and_b32_dpp v42, v38, v30 row_newbcast:0 row_mask:0xf bank_mask:0xf
    v_and_b32_dpp v43, v38, v31 row_newbcast:0 row_mask:0xf bank_mask:0xf
    s_cmp_gt_u32 s64, 233
    s_nop 1
    s_cbranch_scc1 L_wk233
    s_waitcnt vmcnt(4)
L_wk233:
    s_waitcnt vmcnt(6)
    buffer_load_dwordx4 v[228:231], v2, s[48:51], s59 offen nt
    s_xor_b32 s59, s57, 0xa9000
    ds_read_b32 v62, v7 offset:288
    v_mov_b32 v6, 233
    ds_write_b32 v7, v6 offset:272
    v_mfma_f32_16x16x32_bf16 v[48:51], v[40:43], v[192:195], v[48:51]
    v_and_b32_dpp v44, v38, v28 row_newbcast:1 row_mask:0xf bank_mask:0xf
    v_and_b32_dpp v45, v38, v29 row_newbcast:1 row_mask:0xf bank_mask:0xf
    v_and_b32_dpp v46, v38, v30 row_newbcast:1 row_mask:0xf bank_mask:0xf
    v_and_b32_dpp v47, v38, v31 row_newbcast:1 row_mask:0xf bank_mask:0xf
    s_waitcnt lgkmcnt(0)
    v_readfirstlane_b32 s64, v62
    s_cmp_gt_u32 s64, 234
    s_nop 2
    s_cbranch_scc1 L_wk234
    s_waitcnt vmcnt(4)
L_wk234:
    s_waitcnt vmcnt(6)
    buffer_load_dwordx4 v[232:235], v2, s[48:51], s59 offen nt
    s_xor_b32 s59, s57, 0xab000
    v_mov_b32 v6, 234
    ds_write_b32 v7, v6 offset:272
    v_mfma_f32_16x16x32_bf16 v[48:51], v[44:47], v[196:199], v[48:51]
    v_and_b32_dpp v40, v38, v28 row_newbcast:2 row_mask:0xf bank_mask:0xf
    v_and_b32_dpp v41, v38, v29 row_newbcast:2 row_mask:0xf bank_mask:0xf
    v_and_b32_dpp v42, v38, v30 row_newbcast:2 row_mask:0xf bank_mask:0xf
    v_and_b32_dpp v43, v38, v31 row_newbcast:2 row_mask:0xf bank_mask:0xf
    s_cmp_gt_u32 s64, 235
    s_nop 1
    s_cbranch_scc1 L_wk235
    s_waitcnt vmcnt(4)
L_wk235:
    s_waitcnt vmcnt(6)
    buffer_load_dwordx4 v[236:239], v2, s[48:51], s59 offen nt
    s_xor_b32 s59, s57, 0xac000
    ds_read_b32 v62, v7 offset:288
    v_mov_b32 v6, 235
    ds_write_b32 v7, v6 offset:272
    v_mfma_f32_16x16x32_bf16 v[48:51], v[40:43], v[200:203], v[48:51]
    v_and_b32_dpp v44, v38, v28 row_newbcast:3 row_mask:0xf bank_mask:0xf
    v_and_b32_dpp v45, v38, v29 row_newbcast:3 row_mask:0xf bank_mask:0xf
    v_and_b32_dpp v46, v38, v30 row_newbcast:3 row_mask:0xf bank_mask:0xf
    v_and_b32_dpp v47, v38, v31 row_newbcast:3 row_mask:0xf bank_mask:0xf
    s_waitcnt lgkmcnt(0)
    v_readfirstlane_b32 s64, v62
    s_cmp_gt_u32 s64, 236
    s_nop 2
    s_cbranch_scc1 L_wk236
    s_waitcnt vmcnt(4)
L_wk236:
    s_waitcnt vmcnt(6)
    buffer_load_dwordx4 v[240:243], v2, s[48:51], s59 offen nt
    s_xor_b32 s59, s57, 0xae000
    v_mov_b32 v6, 236
    ds_write_b32 v7, v6 offset:272
    v_mfma_f32_16x16x32_bf16 v[48:51], v[44:47], v[204:207], v[48:51]
    v_and_b32_dpp v40, v38, v28 row_newbcast:4 row_mask:0xf bank_mask:0xf
    v_and_b32_dpp v41, v38, v29 row_newbcast:4 row_mask:0xf bank_mask:0xf
    v_and_b32_dpp v42, v38, v30 row_newbcast:4 row_mask:0xf bank_mask:0xf
    v_and_b32_dpp v43, v38, v31 row_newbcast:4 row_mask:0xf bank_mask:0xf
    s_cmp_gt_u32 s64, 237
    s_nop 1
    s_cbranch_scc1 L_wk237
    s_waitcnt vmcnt(4)
L_wk237:
    s_waitcnt vmcnt(6)
    buffer_load_dwordx4 v[244:247], v2, s[48:51], s59 offen nt
    s_xor_b32 s59, s57, 0xad000
    ds_read_b32 v62, v7 offset:288
    v_mov_b32 v6, 237
    ds_write_b32 v7, v6 offset:272
    v_mfma_f32_16x16x32_bf16 v[48:51], v[40:43], v[208:211], v[48:51]
    v_and_b32_dpp v44, v38, v28 row_newbcast:5 row_mask:0xf bank_mask:0xf
    v_and_b32_dpp v45, v38, v29 row_newbcast:5 row_mask:0xf bank_mask:0xf
    v_and_b32_dpp v46, v38, v30 row_newbcast:5 row_mask:0xf bank_mask:0xf
    v_and_b32_dpp v47, v38, v31 row_newbcast:5 row_mask:0xf bank_mask:0xf
    s_waitcnt lgkmcnt(0)
    v_readfirstlane_b32 s64, v62
    s_cmp_gt_u32 s64, 238
    s_nop 2
    s_cbranch_scc1 L_wk238
    s_waitcnt vmcnt(4)
L_wk238:
    s_waitcnt vmcnt(6)
    buffer_load_dwordx4 v[248:251], v2, s[48:51], s59 offen nt
    s_xor_b32 s59, s57, 0xaf000
    v_mov_b32 v6, 238
    ds_write_b32 v7, v6 offset:272
    s_mov_b32 s44, s32
    s_mov_b32 s45, s33
    s_mov_b32 s46, 0x200000
    s_mov_b32 s47, 0x20000
    s_mov_b32 s40, s28
    s_mov_b32 s41, s29
    s_mov_b32 s42, 4096
    s_waitcnt lgkmcnt(0)
    v_readfirstlane_b32 s4, v5
    v_mfma_f32_16x16x32_bf16 v[48:51], v[44:47], v[212:215], v[48:51]
    v_and_b32_dpp v40, v38, v28 row_newbcast:6 row_mask:0xf bank_mask:0xf
    v_and_b32_dpp v41, v38, v29 row_newbcast:6 row_mask:0xf bank_mask:0xf
    v_and_b32_dpp v42, v38, v30 row_newbcast:6 row_mask:0xf bank_mask:0xf
    v_and_b32_dpp v43, v38, v31 row_newbcast:6 row_mask:0xf bank_mask:0xf
    s_cmp_gt_u32 s64, 239
    s_nop 1
    s_cbranch_scc1 L_wk239
    s_waitcnt vmcnt(4)
L_wk239:
    s_waitcnt vmcnt(6)
    buffer_load_dwordx4 v[252:255], v2, s[48:51], s59 offen nt
    s_xor_b32 s59, s57, 0xe0000
    ds_read_b32 v62, v7 offset:288
    v_mov_b32 v6, 239
    ds_write_b32 v7, v6 offset:272
    s_lshl_b32 s67, s34, 1
    s_and_b32 s5, s4, 0xff
    s_add_u32 s67, s67, s38
    s_lshl_b32 s8, s37, 17
    s_and_b32 s39, s67, 7
    s_lshl_b32 s39, s39, 7
    s_add_u32 s8, s8, s39
    s_lshl_b32 s39, s56, 5
    s_add_u32 s8, s8, s39
    s_lshr_b32 s39, s34, 2
    s_lshl_b32 s39, s39, 13
    s_add_u32 s8, s8, s39
    s_add_u32 s8, s8, 1048576
    v_bfe_u32 v8, v1, 1, 3
    v_lshrrev_b32 v9, 4, v1
    v_lshl_add_u32 v8, v9, 4, v8
    v_lshlrev_b32 v8, 10, v8
    v_and_b32 v9, 1, v1
    v_lshl_add_u32 v8, v9, 4, v8
    v_mov_b32 v11, 0
    s_mov_b32 s72, 131072
    s_nop 0
L_sw:
    ds_read_b32 v10, v11 offset:260
    s_waitcnt lgkmcnt(0)
    v_readfirstlane_b32 s39, v10
    s_cmp_lg_u32 s39, 0
    s_nop 2
    s_cbranch_scc1 L_swd
    s_sleep 2
    s_sub_u32 s72, s72, 1
    s_cbranch_scc0 L_sw
L_swd:
    s_and_b32 s39, s39, 0x2000
    s_xor_b32 s8, s8, s39
    s_add_u32 s9, s8, 0x10000
    v_mfma_f32_16x16x32_bf16 v[48:51], v[40:43], v[216:219], v[48:51]
    v_and_b32_dpp v44, v38, v28 row_newbcast:7 row_mask:0xf bank_mask:0xf
    v_and_b32_dpp v45, v38, v29 row_newbcast:7 row_mask:0xf bank_mask:0xf
    v_and_b32_dpp v46, v38, v30 row_newbcast:7 row_mask:0xf bank_mask:0xf
    v_and_b32_dpp v47, v38, v31 row_newbcast:7 row_mask:0xf bank_mask:0xf
    s_waitcnt lgkmcnt(0)
    v_readfirstlane_b32 s64, v62
    s_cmp_gt_u32 s64, 240
    s_nop 2
    s_cbranch_scc1 L_wk240
    s_waitcnt vmcnt(4)
L_wk240:
    s_waitcnt vmcnt(6)
    buffer_load_dwordx4 v[64:67], v2, s[48:51], s59 offen nt
    s_xor_b32 s59, s57, 0xe2000
    v_mov_b32 v6, 240
    ds_write_b32 v7, v6 offset:272
    v_and_b32 v10, 0x31, v1
    s_lshl_b32 s39, s56, 1
    v_add_lshl_u32 v10, v10, s39, 2
    v_lshrrev_b32 v11, 4, v1
    v_lshl_add_u32 v9, v11, 2, v9
    v_lshlrev_b32 v9, 1, v9
    v_mfma_f32_16x16x32_bf16 v[48:51], v[44:47], v[220:223], v[48:51]
    v_and_b32_dpp v40, v38, v28 row_newbcast:8 row_mask:0xf bank_mask:0xf
    v_and_b32_dpp v41, v38, v29 row_newbcast:8 row_mask:0xf bank_mask:0xf
    v_and_b32_dpp v42, v38, v30 row_newbcast:8 row_mask:0xf bank_mask:0xf
    v_and_b32_dpp v43, v38, v31 row_newbcast:8 row_mask:0xf bank_mask:0xf
    s_cmp_gt_u32 s64, 241
    s_nop 1
    s_cbranch_scc1 L_wk241
    s_waitcnt vmcnt(4)
L_wk241:
    s_waitcnt vmcnt(6)
    buffer_load_dwordx4 v[68:71], v2, s[48:51], s59 offen nt
    s_xor_b32 s59, s57, 0xe1000
    ds_read_b32 v62, v7 offset:288
    v_mov_b32 v6, 241
    ds_write_b32 v7, v6 offset:272
    s_lshl_b32 s71, s37, 10
    s_lshl_b32 s39, s67, 6
    s_add_u32 s71, s71, s39
    s_lshr_b32 s39, s56, 1
    s_lshl_b32 s39, s39, 5
    s_add_u32 s71, s71, s39
    s_and_b32 s39, s56, 1
    s_lshl_b32 s39, s39, 2
    s_add_u32 s71, s71, s39
    s_mov_b32 s69, 0xff
    s_mov_b32 s72, 131072
    s_and_b32 s39, s35, 6
    s_cselect_b64 vcc, 0, -1
    v_mfma_f32_16x16x32_bf16 v[48:51], v[40:43], v[224:227], v[48:51]
    v_and_b32_dpp v44, v38, v28 row_newbcast:9 row_mask:0xf bank_mask:0xf
    v_and_b32_dpp v45, v38, v29 row_newbcast:9 row_mask:0xf bank_mask:0xf
    v_and_b32_dpp v46, v38, v30 row_newbcast:9 row_mask:0xf bank_mask:0xf
    v_and_b32_dpp v47, v38, v31 row_newbcast:9 row_mask:0xf bank_mask:0xf
    s_waitcnt lgkmcnt(0)
    v_readfirstlane_b32 s64, v62
    s_cmp_gt_u32 s64, 242
    s_nop 2
    s_cbranch_scc1 L_wk242
    s_waitcnt vmcnt(4)
L_wk242:
    s_waitcnt vmcnt(6)
    buffer_load_dwordx4 v[72:75], v2, s[48:51], s59 offen nt
    s_xor_b32 s59, s57, 0xe3000
    v_mov_b32 v6, 242
    ds_write_b32 v7, v6 offset:272
    v_not_b32 v128, s5
    v_not_b32 v129, s5
    v_not_b32 v130, s5
    v_not_b32 v131, s5
    v_not_b32 v132, s5
    v_not_b32 v133, s5
    v_not_b32 v134, s5
    v_not_b32 v135, s5
    v_mfma_f32_16x16x32_bf16 v[48:51], v[44:47], v[228:231], v[48:51]
    v_and_b32_dpp v40, v38, v28 row_newbcast:10 row_mask:0xf bank_mask:0xf
    v_and_b32_dpp v41, v38, v29 row_newbcast:10 row_mask:0xf bank_mask:0xf
    v_and_b32_dpp v42, v38, v30 row_newbcast:10 row_mask:0xf bank_mask:0xf
    v_and_b32_dpp v43, v38, v31 row_newbcast:10 row_mask:0xf bank_mask:0xf
    s_cmp_gt_u32 s64, 243
    s_nop 1
    s_cbranch_scc1 L_wk243
    s_waitcnt vmcnt(4)
L_wk243:
    s_waitcnt vmcnt(6)
    buffer_load_dwordx4 v[76:79], v2, s[48:51], s59 offen nt
    s_xor_b32 s59, s57, 0xe4000
    v_mov_b32 v6, 243
    ds_write_b32 v7, v6 offset:272
    buffer_load_dwordx4 v[80:83], v2, s[48:51], s59 offen nt
    s_xor_b32 s59, s57, 0xe6000
    v_mov_b32 v6, 244
    ds_write_b32 v7, v6 offset:272
    v_mfma_f32_16x16x32_bf16 v[48:51], v[40:43], v[232:235], v[48:51]
    v_and_b32_dpp v44, v38, v28 row_newbcast:11 row_mask:0xf bank_mask:0xf
    v_and_b32_dpp v45, v38, v29 row_newbcast:11 row_mask:0xf bank_mask:0xf
    v_and_b32_dpp v46, v38, v30 row_newbcast:11 row_mask:0xf bank_mask:0xf
    v_and_b32_dpp v47, v38, v31 row_newbcast:11 row_mask:0xf bank_mask:0xf
    buffer_load_dwordx4 v[84:87], v2, s[48:51], s59 offen nt
    s_xor_b32 s59, s57, 0xe5000
    v_mov_b32 v6, 245
    ds_write_b32 v7, v6 offset:272
    buffer_load_dwordx4 v[88:91], v2, s[48:51], s59 offen nt
    s_xor_b32 s59, s57, 0xe7000
    v_mov_b32 v6, 246
    ds_write_b32 v7, v6 offset:272
    v_mfma_f32_16x16x32_bf16 v[48:51], v[44:47], v[236:239], v[48:51]
    v_and_b32_dpp v40, v38, v28 row_newbcast:12 row_mask:0xf bank_mask:0xf
    v_and_b32_dpp v41, v38, v29 row_newbcast:12 row_mask:0xf bank_mask:0xf
    v_and_b32_dpp v42, v38, v30 row_newbcast:12 row_mask:0xf bank_mask:0xf
    v_and_b32_dpp v43, v38, v31 row_newbcast:12 row_mask:0xf bank_mask:0xf
    s_waitcnt vmcnt(9)
    buffer_load_dwordx4 v[92:95], v2, s[48:51], s59 offen nt
    s_xor_b32 s59, s57, 0xe8000
    v_mov_b32 v6, 247
    ds_write_b32 v7, v6 offset:272
    v_mfma_f32_16x16x32_bf16 v[48:51], v[40:43], v[240:243], v[48:51]
    v_and_b32_dpp v44, v38, v28 row_newbcast:13 row_mask:0xf bank_mask:0xf
    v_and_b32_dpp v45, v38, v29 row_newbcast:13 row_mask:0xf bank_mask:0xf
    v_and_b32_dpp v46, v38, v30 row_newbcast:13 row_mask:0xf bank_mask:0xf
    v_and_b32_dpp v47, v38, v31 row_newbcast:13 row_mask:0xf bank_mask:0xf
    s_waitcnt vmcnt(9)
    buffer_load_dwordx4 v[96:99], v2, s[48:51], s59 offen nt
    s_xor_b32 s59, s57, 0xea000
    v_mov_b32 v6, 248
    ds_write_b32 v7, v6 offset:272
    v_mfma_f32_16x16x32_bf16 v[48:51], v[44:47], v[244:247], v[48:51]
    v_and_b32_dpp v40, v38, v28 row_newbcast:14 row_mask:0xf bank_mask:0xf
    v_and_b32_dpp v41, v38, v29 row_newbcast:14 row_mask:0xf bank_mask:0xf
    v_and_b32_dpp v42, v38, v30 row_newbcast:14 row_mask:0xf bank_mask:0xf
    v_and_b32_dpp v43, v38, v31 row_newbcast:14 row_mask:0xf bank_mask:0xf
    s_waitcnt vmcnt(9)
    buffer_load_dwordx4 v[100:103], v2, s[48:51], s59 offen nt
    s_xor_b32 s59, s57, 0xe9000
    v_mov_b32 v6, 249
    ds_write_b32 v7, v6 offset:272
    v_mfma_f32_16x16x32_bf16 v[48:51], v[40:43], v[248:251], v[48:51]
    v_and_b32_dpp v44, v38, v28 row_newbcast:15 row_mask:0xf bank_mask:0xf
    v_and_b32_dpp v45, v38, v29 row_newbcast:15 row_mask:0xf bank_mask:0xf
    v_and_b32_dpp v46, v38, v30 row_newbcast:15 row_mask:0xf bank_mask:0xf
    v_and_b32_dpp v47, v38, v31 row_newbcast:15 row_mask:0xf bank_mask:0xf
    s_waitcnt vmcnt(9)
    buffer_load_dwordx4 v[104:107], v2, s[48:51], s59 offen nt
    s_xor_b32 s59, s57, 0xeb000
    v_mov_b32 v6, 250
    ds_write_b32 v7, v6 offset:272
    v_mfma_f32_16x16x32_bf16 v[48:51], v[44:47], v[252:255], v[48:51]
    v_and_b32_dpp v40, v39, v28 row_newbcast:0 row_mask:0xf bank_mask:0xf
    v_and_b32_dpp v41, v39, v29 row_newbcast:0 row_mask:0xf bank_mask:0xf
    v_and_b32_dpp v42, v39, v30 row_newbcast:0 row_mask:0xf bank_mask:0xf
    v_and_b32_dpp v43, v39, v31 row_newbcast:0 row_mask:0xf bank_mask:0xf
    s_waitcnt vmcnt(9)
    buffer_load_dwordx4 v[108:111], v2, s[48:51], s59 offen nt
    s_xor_b32 s59, s57, 0xec000
    v_mov_b32 v6, 251
    ds_write_b32 v7, v6 offset:272
    v_mfma_f32_16x16x32_bf16 v[48:51], v[40:43], v[64:67], v[48:51]
    v_and_b32_dpp v44, v39, v28 row_newbcast:1 row_mask:0xf bank_mask:0xf
    v_and_b32_dpp v45, v39, v29 row_newbcast:1 row_mask:0xf bank_mask:0xf
    v_and_b32_dpp v46, v39, v30 row_newbcast:1 row_mask:0xf bank_mask:0xf
    v_and_b32_dpp v47, v39, v31 row_newbcast:1 row_mask:0xf bank_mask:0xf
    s_waitcnt vmcnt(9)
    buffer_load_dwordx4 v[112:115], v2, s[48:51], s59 offen nt
    s_xor_b32 s59, s57, 0xee000
    v_mov_b32 v6, 252
    ds_write_b32 v7, v6 offset:272
    v_mfma_f32_16x16x32_bf16 v[48:51], v[44:47], v[68:71], v[48:51]
    v_and_b32_dpp v40, v39, v28 row_newbcast:2 row_mask:0xf bank_mask:0xf
    v_and_b32_dpp v41, v39, v29 row_newbcast:2 row_mask:0xf bank_mask:0xf
    v_and_b32_dpp v42, v39, v30 row_newbcast:2 row_mask:0xf bank_mask:0xf
    v_and_b32_dpp v43, v39, v31 row_newbcast:2 row_mask:0xf bank_mask:0xf
    s_waitcnt vmcnt(9)
    buffer_load_dwordx4 v[116:119], v2, s[48:51], s59 offen nt
    s_xor_b32 s59, s57, 0xed000
    v_mov_b32 v6, 253
    ds_write_b32 v7, v6 offset:272
    v_mfma_f32_16x16x32_bf16 v[48:51], v[40:43], v[72:75], v[48:51]
    v_and_b32_dpp v44, v39, v28 row_newbcast:3 row_mask:0xf bank_mask:0xf
    v_and_b32_dpp v45, v39, v29 row_newbcast:3 row_mask:0xf bank_mask:0xf
    v_and_b32_dpp v46, v39, v30 row_newbcast:3 row_mask:0xf bank_mask:0xf
    v_and_b32_dpp v47, v39, v31 row_newbcast:3 row_mask:0xf bank_mask:0xf
    s_waitcnt vmcnt(9)
    buffer_load_dwordx4 v[120:123], v2, s[48:51], s59 offen nt
    s_xor_b32 s59, s57, 0xef000
    v_mov_b32 v6, 254
    ds_write_b32 v7, v6 offset:272
    v_mfma_f32_16x16x32_bf16 v[48:51], v[44:47], v[76:79], v[48:51]
    v_and_b32_dpp v40, v39, v28 row_newbcast:4 row_mask:0xf bank_mask:0xf
    v_and_b32_dpp v41, v39, v29 row_newbcast:4 row_mask:0xf bank_mask:0xf
    v_and_b32_dpp v42, v39, v30 row_newbcast:4 row_mask:0xf bank_mask:0xf
    v_and_b32_dpp v43, v39, v31 row_newbcast:4 row_mask:0xf bank_mask:0xf
    s_waitcnt vmcnt(9)
    buffer_load_dwordx4 v[124:127], v2, s[48:51], s59 offen nt
    v_mov_b32 v6, 255
    ds_write_b32 v7, v6 offset:272
    v_mfma_f32_16x16x32_bf16 v[48:51], v[40:43], v[80:83], v[48:51]
    v_and_b32_dpp v44, v39, v28 row_newbcast:5 row_mask:0xf bank_mask:0xf
    v_and_b32_dpp v45, v39, v29 row_newbcast:5 row_mask:0xf bank_mask:0xf
    v_and_b32_dpp v46, v39, v30 row_newbcast:5 row_mask:0xf bank_mask:0xf
    v_and_b32_dpp v47, v39, v31 row_newbcast:5 row_mask:0xf bank_mask:0xf
    s_nop 1
    v_mfma_f32_16x16x32_bf16 v[48:51], v[44:47], v[84:87], v[48:51]
    v_and_b32_dpp v40, v39, v28 row_newbcast:6 row_mask:0xf bank_mask:0xf
    v_and_b32_dpp v41, v39, v29 row_newbcast:6 row_mask:0xf bank_mask:0xf
    v_and_b32_dpp v42, v39, v30 row_newbcast:6 row_mask:0xf bank_mask:0xf
    v_and_b32_dpp v43, v39, v31 row_newbcast:6 row_mask:0xf bank_mask:0xf
    s_waitcnt vmcnt(9)
    s_nop 0
    v_mfma_f32_16x16x32_bf16 v[48:51], v[40:43], v[88:91], v[48:51]
    v_and_b32_dpp v44, v39, v28 row_newbcast:7 row_mask:0xf bank_mask:0xf
    v_and_b32_dpp v45, v39, v29 row_newbcast:7 row_mask:0xf bank_mask:0xf
    v_and_b32_dpp v46, v39, v30 row_newbcast:7 row_mask:0xf bank_mask:0xf
    v_and_b32_dpp v47, v39, v31 row_newbcast:7 row_mask:0xf bank_mask:0xf
    s_waitcnt vmcnt(8)
    s_nop 0
    v_mfma_f32_16x16x32_bf16 v[48:51], v[44:47], v[92:95], v[48:51]
    v_and_b32_dpp v40, v39, v28 row_newbcast:8 row_mask:0xf bank_mask:0xf
    v_and_b32_dpp v41, v39, v29 row_newbcast:8 row_mask:0xf bank_mask:0xf
    v_and_b32_dpp v42, v39, v30 row_newbcast:8 row_mask:0xf bank_mask:0xf
    v_and_b32_dpp v43, v39, v31 row_newbcast:8 row_mask:0xf bank_mask:0xf
    s_waitcnt vmcnt(7)
    s_nop 0
    v_mfma_f32_16x16x32_bf16 v[48:51], v[40:43], v[96:99], v[48:51]
    v_and_b32_dpp v44, v39, v28 row_newbcast:9 row_mask:0xf bank_mask:0xf
    v_and_b32_dpp v45, v39, v29 row_newbcast:9 row_mask:0xf bank_mask:0xf
    v_and_b32_dpp v46, v39, v30 row_newbcast:9 row_mask:0xf bank_mask:0xf
    v_and_b32_dpp v47, v39, v31 row_newbcast:9 row_mask:0xf bank_mask:0xf
    s_waitcnt vmcnt(6)
    s_nop 0
    v_mfma_f32_16x16x32_bf16 v[48:51], v[44:47], v[100:103], v[48:51]
    v_and_b32_dpp v40, v39, v28 row_newbcast:10 row_mask:0xf bank_mask:0xf
    v_and_b32_dpp v41, v39, v29 row_newbcast:10 row_mask:0xf bank_mask:0xf
    v_and_b32_dpp v42, v39, v30 row_newbcast:10 row_mask:0xf bank_mask:0xf
    v_and_b32_dpp v43, v39, v31 row_newbcast:10 row_mask:0xf bank_mask:0xf
    s_waitcnt vmcnt(5)
    s_nop 0
    v_mfma_f32_16x16x32_bf16 v[48:51], v[40:43], v[104:107], v[48:51]
    v_and_b32_dpp v44, v39, v28 row_newbcast:11 row_mask:0xf bank_mask:0xf
    v_and_b32_dpp v45, v39, v29 row_newbcast:11 row_mask:0xf bank_mask:0xf
    v_and_b32_dpp v46, v39, v30 row_newbcast:11 row_mask:0xf bank_mask:0xf
    v_and_b32_dpp v47, v39, v31 row_newbcast:11 row_mask:0xf bank_mask:0xf
    s_waitcnt vmcnt(4)
    s_nop 0
    v_mfma_f32_16x16x32_bf16 v[48:51], v[44:47], v[108:111], v[48:51]
    v_and_b32_dpp v40, v39, v28 row_newbcast:12 row_mask:0xf bank_mask:0xf
    v_and_b32_dpp v41, v39, v29 row_newbcast:12 row_mask:0xf bank_mask:0xf
    v_and_b32_dpp v42, v39, v30 row_newbcast:12 row_mask:0xf bank_mask:0xf
    v_and_b32_dpp v43, v39, v31 row_newbcast:12 row_mask:0xf bank_mask:0xf
    s_waitcnt vmcnt(3)
    s_nop 0
    v_mfma_f32_16x16x32_bf16 v[48:51], v[40:43], v[112:115], v[48:51]
    v_and_b32_dpp v44, v39, v28 row_newbcast:13 row_mask:0xf bank_mask:0xf
    v_and_b32_dpp v45, v39, v29 row_newbcast:13 row_mask:0xf bank_mask:0xf
    v_and_b32_dpp v46, v39, v30 row_newbcast:13 row_mask:0xf bank_mask:0xf
    v_and_b32_dpp v47, v39, v31 row_newbcast:13 row_mask:0xf bank_mask:0xf
    s_nop 2
    s_cbranch_vccz L_nf
    buffer_load_dwordx4 v[128:131], v8, s[44:47], s8 offen sc1
    buffer_load_dwordx4 v[132:135], v8, s[44:47], s9 offen sc1
    s_waitcnt vmcnt(4)
    v_mfma_f32_16x16x32_bf16 v[48:51], v[44:47], v[116:119], v[48:51]
    v_and_b32_dpp v40, v39, v28 row_newbcast:14 row_mask:0xf bank_mask:0xf
    v_and_b32_dpp v41, v39, v29 row_newbcast:14 row_mask:0xf bank_mask:0xf
    v_and_b32_dpp v42, v39, v30 row_newbcast:14 row_mask:0xf bank_mask:0xf
    v_and_b32_dpp v43, v39, v31 row_newbcast:14 row_mask:0xf bank_mask:0xf
    s_waitcnt vmcnt(3)
    s_nop 0
    v_mfma_f32_16x16x32_bf16 v[48:51], v[40:43], v[120:123], v[48:51]
    v_and_b32_dpp v44, v39, v28 row_newbcast:15 row_mask:0xf bank_mask:0xf
    v_and_b32_dpp v45, v39, v29 row_newbcast:15 row_mask:0xf bank_mask:0xf
    v_and_b32_dpp v46, v39, v30 row_newbcast:15 row_mask:0xf bank_mask:0xf
    v_and_b32_dpp v47, v39, v31 row_newbcast:15 row_mask:0xf bank_mask:0xf
    s_waitcnt vmcnt(2)
    s_nop 0
    v_mfma_f32_16x16x32_bf16 v[48:51], v[44:47], v[124:127], v[48:51]
    s_nop 6
    s_branch L_nj
L_nf:
    s_waitcnt vmcnt(2)
    v_mfma_f32_16x16x32_bf16 v[48:51], v[44:47], v[116:119], v[48:51]
    v_and_b32_dpp v40, v39, v28 row_newbcast:14 row_mask:0xf bank_mask:0xf
    v_and_b32_dpp v41, v39, v29 row_newbcast:14 row_mask:0xf bank_mask:0xf
    v_and_b32_dpp v42, v39, v30 row_newbcast:14 row_mask:0xf bank_mask:0xf
    v_and_b32_dpp v43, v39, v31 row_newbcast:14 row_mask:0xf bank_mask:0xf
    s_waitcnt vmcnt(1)
    s_nop 0
    v_mfma_f32_16x16x32_bf16 v[48:51], v[40:43], v[120:123], v[48:51]
    v_and_b32_dpp v44, v39, v28 row_newbcast:15 row_mask:0xf bank_mask:0xf
    v_and_b32_dpp v45, v39, v29 row_newbcast:15 row_mask:0xf bank_mask:0xf
    v_and_b32_dpp v46, v39, v30 row_newbcast:15 row_mask:0xf bank_mask:0xf
    v_and_b32_dpp v47, v39, v31 row_newbcast:15 row_mask:0xf bank_mask:0xf
    s_waitcnt vmcnt(0)
    s_nop 0
    v_mfma_f32_16x16x32_bf16 v[48:51], v[44:47], v[124:127], v[48:51]
    s_nop 7
L_nj:
    v_cvt_pk_bf16_f32 v52, v48, v49
    v_cvt_pk_bf16_f32 v53, v50, v51
    s_mov_b32 exec_hi, 0
    ds_write2_b32 v3, v52, v53 offset1:4
    s_mov_b64 exec, -1
    s_waitcnt lgkmcnt(0)
    s_barrier
    s_cbranch_vccz L_end
    ds_read_b32 v45, v10 offset:3456
    s_barrier
L_fp:
    v_xor_b32 v40, s5, v128
    v_xor_b32 v41, s5, v132
    v_bitop3_b32 v40, v129, v40, s5 bitop3:0xde
    v_bitop3_b32 v41, v133, v41, s5 bitop3:0xde
    v_bitop3_b32 v40, v130, v40, s5 bitop3:0xde
    v_bitop3_b32 v41, v134, v41, s5 bitop3:0xde
    v_bitop3_b32 v40, v131, v40, s5 bitop3:0xde
    v_bitop3_b32 v41, v135, v41, s5 bitop3:0xde
    v_bitop3_b32 v40, v40, v41, s69 bitop3:0xa8
    v_xor_b32 v160, s5, v128
    v_xor_b32 v164, s5, v132
    v_or_b32_dpp v40, v40, v40 quad_perm:[1,0,3,2] row_mask:0xf bank_mask:0xf
    v_cmp_ne_u32 vcc, 0, v40
    v_xor_b32 v161, s5, v129
    v_xor_b32 v165, s5, v133
    s_nop 0
    s_cbranch_vccz L_fpd
    s_mov_b64 exec, vcc
    buffer_load_dwordx4 v[128:131], v8, s[44:47], s8 offen sc1
    buffer_load_dwordx4 v[132:135], v8, s[44:47], s9 offen sc1
    s_mov_b64 exec, -1
    s_sub_u32 s72, s72, 1
    s_waitcnt vmcnt(2)
    s_cbranch_scc0 L_fp
L_fpd:
    ds_read_b32 v44, v10 offset:3200
    v_xor_b32 v162, s5, v130
    v_xor_b32 v166, s5, v134
    v_xor_b32 v163, s5, v131
    v_xor_b32 v167, s5, v135
    v_pk_add_f32 v[160:161], v[160:161], v[164:165]
    v_pk_add_f32 v[162:163], v[162:163], v[166:167]
    s_nop 1
    v_permlane32_swap_b32 v160, v162
    v_permlane32_swap_b32 v161, v163
    v_add_f32 v160, v160, v162
    v_add_f32 v161, v161, v163
    s_nop 1
    v_permlane16_swap_b32 v160, v161
    v_add_f32 v160, v160, v161
    s_nop 1
    v_add_f32_dpp v160, v160, v160 row_ror:8 row_mask:0xf bank_mask:0xf
    s_nop 1
    v_add_f32_dpp v160, v160, v160 row_ror:4 row_mask:0xf bank_mask:0xf
    s_waitcnt lgkmcnt(0)
    v_cmp_eq_u32 vcc, -1, v44
    v_add_f32_dpp v160, v160, v160 row_ror:2 row_mask:0xf bank_mask:0xf
    v_cvt_pk_bf16_f32 v160, v160, v160
    v_and_b32 v160, 0xffff0000, v160
    s_nop 0
    s_cbranch_vccnz L_gq
L_gr:
    v_mul_f32 v160, v160, v44
    v_cvt_pk_bf16_f32 v160, v160, v160
    v_and_b32 v160, 0xffff0000, v160
    v_add_f32 v160, v160, v45
    v_cvt_pk_bf16_f32 v160, v160, v160
    s_mov_b32 exec_lo, 0x00030003
    s_mov_b32 exec_hi, 0x00030003
    buffer_store_short v160, v9, s[40:43], s71 offen
    s_or_b32 s39, s2, s56
    s_cbranch_scc1 L_fend
    v_mov_b32 v41, s4
    s_mov_b64 exec, 1
    buffer_store_dword v41, off, s[44:47], 0 offset:0
L_fend:
    s_endpgm
L_gq:
    s_mov_b32 s72, 2097152
L_gq2:
    ds_read_b32 v44, v10 offset:3200
    s_waitcnt lgkmcnt(0)
    v_cmp_eq_u32 vcc, -1, v44
    s_nop 0
    s_cbranch_vccz L_gr
    s_sub_u32 s72, s72, 1
    s_cbranch_scc0 L_gq2
    s_branch L_gr
L_H:
    v_lshlrev_b32 v2, 4, v1
    v_and_b32 v3, 15, v1
    v_lshrrev_b32 v4, 4, v1
    v_mov_b32 v29, 0xff
    s_mov_b32 s67, 0
    v_mov_b32 v20, 0
    s_mov_b64 s[64:65], 0
    s_cmp_lg_u32 s3, 0
    s_cbranch_scc1 L_H1
    s_lshl_b32 s57, s36, 2
    s_add_u32 s57, s57, s37
    s_lshl_b32 s57, s57, 1
    s_add_u32 s57, s57, s38
    s_mov_b32 m0, 4096
    s_lshl_b32 s60, s37, 20
    s_lshl_b32 s39, s36, 8
    s_add_u32 s60, s60, s39
    s_lshl_b32 s39, s38, 7
    s_add_u32 s60, s60, s39
    s_mov_b32 s61, 65536
    v_lshrrev_b32 v30, 3, v1
    v_and_b32 v31, 7, v1
    v_lshlrev_b32 v31, 4, v31
    v_lshl_add_u32 v7, v30, 13, v31
    v_and_b32 v33, 3, v1
    v_lshlrev_b32 v5, 10, v33
    v_bfe_u32 v34, v1, 2, 2
    v_lshl_add_u32 v5, v34, 6, v5
    v_lshl_add_u32 v5, v4, 4, v5
    s_waitcnt lgkmcnt(0)
    s_mov_b32 s40, s8
    s_mov_b32 s41, s9
    s_mov_b32 s42, 0x1000
    s_mov_b32 s43, 0x20000
    s_mov_b32 s48, s14
    s_mov_b32 s49, s15
    s_mov_b32 s50, 0x400000
    s_mov_b32 s51, 0x20000
    buffer_load_dwordx4 v[8:11], v5, s[40:43], 0 offen offset:0
    buffer_load_dwordx4 v[12:15], v5, s[40:43], 0 offen offset:256
    buffer_load_dwordx4 v[16:19], v5, s[40:43], 0 offen offset:512
    buffer_load_dwordx4 v[20:23], v5, s[40:43], 0 offen offset:768
    buffer_load_dwordx4 v7, s[48:51], s60 offen nt lds
    s_add_u32 s60, s60, s61
    s_add_u32 m0, m0, 0x400
    s_nop 0
    buffer_load_dwordx4 v7, s[48:51], s60 offen nt lds
    s_add_u32 s60, s60, s61
    s_add_u32 m0, m0, 0x400
    s_nop 0
    buffer_load_dwordx4 v7, s[48:51], s60 offen nt lds
    s_add_u32 s60, s60, s61
    s_add_u32 m0, m0, 0x400
    s_nop 0
    buffer_load_dwordx4 v7, s[48:51], s60 offen nt lds
    s_add_u32 s60, s60, s61
    s_add_u32 m0, m0, 0x400
    s_barrier
    buffer_load_dwordx4 v7, s[48:51], s60 offen nt lds
    s_add_u32 s60, s60, s61
    s_add_u32 m0, m0, 0x400
    s_nop 0
    buffer_load_dwordx4 v7, s[48:51], s60 offen nt lds
    s_add_u32 s60, s60, s61
    s_add_u32 m0, m0, 0x400
    s_nop 0
    buffer_load_dwordx4 v7, s[48:51], s60 offen nt lds
    s_add_u32 s60, s60, s61
    s_add_u32 m0, m0, 0x400
    s_nop 0
    buffer_load_dwordx4 v7, s[48:51], s60 offen nt lds
    s_add_u32 s60, s60, s61
    s_add_u32 m0, m0, 0x400
    s_nop 0
    buffer_load_dwordx4 v7, s[48:51], s60 offen nt lds
    s_add_u32 s60, s60, s61
    s_add_u32 m0, m0, 0x400
    s_nop 0
    buffer_load_dwordx4 v7, s[48:51], s60 offen nt lds
    s_add_u32 s60, s60, s61
    s_add_u32 m0, m0, 0x400
    s_nop 0
    buffer_load_dwordx4 v7, s[48:51], s60 offen nt lds
    s_add_u32 s60, s60, s61
    s_add_u32 m0, m0, 0x400
    s_nop 0
    buffer_load_dwordx4 v7, s[48:51], s60 offen nt lds
    s_add_u32 s60, s60, s61
    s_add_u32 m0, m0, 0x400
    s_nop 0
    buffer_load_dwordx4 v7, s[48:51], s60 offen nt lds
    s_add_u32 s60, s60, s61
    s_add_u32 m0, m0, 0x400
    s_nop 0
    buffer_load_dwordx4 v7, s[48:51], s60 offen nt lds
    s_add_u32 s60, s60, s61
    s_add_u32 m0, m0, 0x400
    s_nop 0
    buffer_load_dwordx4 v7, s[48:51], s60 offen nt lds
    s_add_u32 s60, s60, s61
    s_add_u32 m0, m0, 0x400
    s_nop 0
    buffer_load_dwordx4 v7, s[48:51], s60 offen nt lds
    s_add_u32 s60, s60, s61
    s_add_u32 m0, m0, 0x400
    s_mov_b32 s44, s32
    s_mov_b32 s45, s33
    s_mov_b32 s46, 0x200000
    s_mov_b32 s47, 0x20000
    s_mul_i32 s57, s57, 1024
    s_add_u32 s57, s57, 1572864
    v_lshl_add_u32 v32, v4, 3, v34
    v_lshlrev_b32 v32, 7, v32
    v_lshl_add_u32 v32, v33, 5, v32
    s_waitcnt vmcnt(16)
    v_lshlrev_b32 v72, 16, v8
    v_and_b32 v73, 0xffff0000, v8
    v_lshlrev_b32 v74, 16, v9
    v_and_b32 v75, 0xffff0000, v9
    v_lshlrev_b32 v76, 16, v10
    v_and_b32 v77, 0xffff0000, v10
    v_lshlrev_b32 v78, 16, v11
    v_and_b32 v79, 0xffff0000, v11
    v_lshlrev_b32 v80, 16, v12
    v_and_b32 v81, 0xffff0000, v12
    v_lshlrev_b32 v82, 16, v13
    v_and_b32 v83, 0xffff0000, v13
    v_lshlrev_b32 v84, 16, v14
    v_and_b32 v85, 0xffff0000, v14
    v_lshlrev_b32 v86, 16, v15
    v_and_b32 v87, 0xffff0000, v15
    v_lshlrev_b32 v88, 16, v16
    v_and_b32 v89, 0xffff0000, v16
    v_lshlrev_b32 v90, 16, v17
    v_and_b32 v91, 0xffff0000, v17
    v_lshlrev_b32 v92, 16, v18
    v_and_b32 v93, 0xffff0000, v18
    v_lshlrev_b32 v94, 16, v19
    v_and_b32 v95, 0xffff0000, v19
    v_lshlrev_b32 v96, 16, v20
    v_and_b32 v97, 0xffff0000, v20
    v_lshlrev_b32 v98, 16, v21
    v_and_b32 v99, 0xffff0000, v21
    v_lshlrev_b32 v100, 16, v22
    v_and_b32 v101, 0xffff0000, v22
    v_lshlrev_b32 v102, 16, v23
    v_and_b32 v103, 0xffff0000, v23
    v_add_f32 v24, v72, v73
    v_add_f32 v27, v74, v75
    v_add_f32 v24, v24, v76
    v_add_f32 v27, v27, v77
    v_add_f32 v24, v24, v78
    v_add_f32 v27, v27, v79
    v_add_f32 v24, v24, v80
    v_add_f32 v27, v27, v81
    v_add_f32 v24, v24, v82
    v_add_f32 v27, v27, v83
    v_add_f32 v24, v24, v84
    v_add_f32 v27, v27, v85
    v_add_f32 v24, v24, v86
    v_add_f32 v27, v27, v87
    v_add_f32 v24, v24, v88
    v_add_f32 v27, v27, v89
    v_add_f32 v24, v24, v90
    v_add_f32 v27, v27, v91
    v_add_f32 v24, v24, v92
    v_add_f32 v27, v27, v93
    v_add_f32 v24, v24, v94
    v_add_f32 v27, v27, v95
    v_add_f32 v24, v24, v96
    v_add_f32 v27, v27, v97
    v_add_f32 v24, v24, v98
    v_add_f32 v27, v27, v99
    v_add_f32 v24, v24, v100
    v_add_f32 v27, v27, v101
    v_add_f32 v24, v24, v102
    v_add_f32 v27, v27, v103
    v_add_f32 v24, v24, v27
    s_nop 1
    v_add_f32_dpp v24, v24, v24 row_ror:4 row_mask:0xf bank_mask:0xf
    s_nop 1
    v_add_f32_dpp v24, v24, v24 row_ror:8 row_mask:0xf bank_mask:0xf
    v_mov_b32 v26, v24
    s_nop 1
    v_permlane16_swap_b32 v24, v26
    v_add_f32 v24, v24, v26
    v_mov_b32 v26, v24
    s_nop 1
    v_permlane32_swap_b32 v24, v26
    v_add_f32 v24, v24, v26
    v_mul_f32 v24, 0x3b000000, v24
    v_sub_f32 v27, v72, v24
    v_sub_f32 v28, v73, v24
    v_mul_f32 v25, v27, v27
    v_mul_f32 v26, v28, v28
    v_sub_f32 v27, v74, v24
    v_sub_f32 v28, v75, v24
    v_fmac_f32 v25, v27, v27
    v_fmac_f32 v26, v28, v28
    v_sub_f32 v27, v76, v24
    v_sub_f32 v28, v77, v24
    v_fmac_f32 v25, v27, v27
    v_fmac_f32 v26, v28, v28
    v_sub_f32 v27, v78, v24
    v_sub_f32 v28, v79, v24
    v_fmac_f32 v25, v27, v27
    v_fmac_f32 v26, v28, v28
    v_sub_f32 v27, v80, v24
    v_sub_f32 v28, v81, v24
    v_fmac_f32 v25, v27, v27
    v_fmac_f32 v26, v28, v28
    v_sub_f32 v27, v82, v24
    v_sub_f32 v28, v83, v24
    v_fmac_f32 v25, v27, v27
    v_fmac_f32 v26, v28, v28
    v_sub_f32 v27, v84, v24
    v_sub_f32 v28, v85, v24
    v_fmac_f32 v25, v27, v27
    v_fmac_f32 v26, v28, v28
    v_sub_f32 v27, v86, v24
    v_sub_f32 v28, v87, v24
    v_fmac_f32 v25, v27, v27
    v_fmac_f32 v26, v28, v28
    v_sub_f32 v27, v88, v24
    v_sub_f32 v28, v89, v24
    v_fmac_f32 v25, v27, v27
    v_fmac_f32 v26, v28, v28
    v_sub_f32 v27, v90, v24
    v_sub_f32 v28, v91, v24
    v_fmac_f32 v25, v27, v27
    v_fmac_f32 v26, v28, v28
    v_sub_f32 v27, v92, v24
    v_sub_f32 v28, v93, v24
    v_fmac_f32 v25, v27, v27
    v_fmac_f32 v26, v28, v28
    v_sub_f32 v27, v94, v24
    v_sub_f32 v28, v95, v24
    v_fmac_f32 v25, v27, v27
    v_fmac_f32 v26, v28, v28
    v_sub_f32 v27, v96, v24
    v_sub_f32 v28, v97, v24
    v_fmac_f32 v25, v27, v27
    v_fmac_f32 v26, v28, v28
    v_sub_f32 v27, v98, v24
    v_sub_f32 v28, v99, v24
    v_fmac_f32 v25, v27, v27
    v_fmac_f32 v26, v28, v28
    v_sub_f32 v27, v100, v24
    v_sub_f32 v28, v101, v24
    v_fmac_f32 v25, v27, v27
    v_fmac_f32 v26, v28, v28
    v_sub_f32 v27, v102, v24
    v_sub_f32 v28, v103, v24
    v_fmac_f32 v25, v27, v27
    v_fmac_f32 v26, v28, v28
    v_add_f32 v25, v25, v26
    s_nop 1
    v_add_f32_dpp v25, v25, v25 row_ror:4 row_mask:0xf bank_mask:0xf
    s_nop 1
    v_add_f32_dpp v25, v25, v25 row_ror:8 row_mask:0xf bank_mask:0xf
    v_mov_b32 v26, v25
    s_nop 1
    v_permlane16_swap_b32 v25, v26
    v_add_f32 v25, v25, v26
    v_mov_b32 v26, v25
    s_nop 1
    v_permlane32_swap_b32 v25, v26
    v_add_f32 v25, v25, v26
    v_mul_f32 v25, 0x3b000000, v25
    v_cvt_pk_bf16_f32 v25, v24, v25
    v_lshlrev_b32 v24, 16, v25
    v_and_b32 v25, 0xffff0000, v25
    v_add_f32 v25, 0x3727c5ac, v25
    v_cvt_pk_bf16_f32 v25, v25, v25
    v_and_b32 v25, 0xffff0000, v25
    v_sqrt_f32 v25, v25
    s_nop 0
    v_cvt_pk_bf16_f32 v25, v25, v25
    v_and_b32 v25, 0xffff0000, v25
    v_rcp_f32 v25, v25
    v_sub_f32 v72, v72, v24
    v_sub_f32 v73, v73, v24
    v_sub_f32 v74, v74, v24
    v_sub_f32 v75, v75, v24
    v_sub_f32 v76, v76, v24
    v_sub_f32 v77, v77, v24
    v_sub_f32 v78, v78, v24
    v_sub_f32 v79, v79, v24
    v_sub_f32 v80, v80, v24
    v_sub_f32 v81, v81, v24
    v_sub_f32 v82, v82, v24
    v_sub_f32 v83, v83, v24
    v_sub_f32 v84, v84, v24
    v_sub_f32 v85, v85, v24
    v_sub_f32 v86, v86, v24
    v_sub_f32 v87, v87, v24
    v_sub_f32 v88, v88, v24
    v_sub_f32 v89, v89, v24
    v_sub_f32 v90, v90, v24
    v_sub_f32 v91, v91, v24
    v_sub_f32 v92, v92, v24
    v_sub_f32 v93, v93, v24
    v_sub_f32 v94, v94, v24
    v_sub_f32 v95, v95, v24
    v_sub_f32 v96, v96, v24
    v_sub_f32 v97, v97, v24
    v_sub_f32 v98, v98, v24
    v_sub_f32 v99, v99, v24
    v_sub_f32 v100, v100, v24
    v_sub_f32 v101, v101, v24
    v_sub_f32 v102, v102, v24
    v_sub_f32 v103, v103, v24
    v_cvt_pk_bf16_f32 v73, v72, v73
    v_lshlrev_b32 v72, 16, v73
    v_and_b32 v73, 0xffff0000, v73
    v_cvt_pk_bf16_f32 v75, v74, v75
    v_lshlrev_b32 v74, 16, v75
    v_and_b32 v75, 0xffff0000, v75
    v_cvt_pk_bf16_f32 v77, v76, v77
    v_lshlrev_b32 v76, 16, v77
    v_and_b32 v77, 0xffff0000, v77
    v_cvt_pk_bf16_f32 v79, v78, v79
    v_lshlrev_b32 v78, 16, v79
    v_and_b32 v79, 0xffff0000, v79
    v_cvt_pk_bf16_f32 v81, v80, v81
    v_lshlrev_b32 v80, 16, v81
    v_and_b32 v81, 0xffff0000, v81
    v_cvt_pk_bf16_f32 v83, v82, v83
    v_lshlrev_b32 v82, 16, v83
    v_and_b32 v83, 0xffff0000, v83
    v_cvt_pk_bf16_f32 v85, v84, v85
    v_lshlrev_b32 v84, 16, v85
    v_and_b32 v85, 0xffff0000, v85
    v_cvt_pk_bf16_f32 v87, v86, v87
    v_lshlrev_b32 v86, 16, v87
    v_and_b32 v87, 0xffff0000, v87
    v_cvt_pk_bf16_f32 v89, v88, v89
    v_lshlrev_b32 v88, 16, v89
    v_and_b32 v89, 0xffff0000, v89
    v_cvt_pk_bf16_f32 v91, v90, v91
    v_lshlrev_b32 v90, 16, v91
    v_and_b32 v91, 0xffff0000, v91
    v_cvt_pk_bf16_f32 v93, v92, v93
    v_lshlrev_b32 v92, 16, v93
    v_and_b32 v93, 0xffff0000, v93
    v_cvt_pk_bf16_f32 v95, v94, v95
    v_lshlrev_b32 v94, 16, v95
    v_and_b32 v95, 0xffff0000, v95
    v_cvt_pk_bf16_f32 v97, v96, v97
    v_lshlrev_b32 v96, 16, v97
    v_and_b32 v97, 0xffff0000, v97
    v_cvt_pk_bf16_f32 v99, v98, v99
    v_lshlrev_b32 v98, 16, v99
    v_and_b32 v99, 0xffff0000, v99
    v_cvt_pk_bf16_f32 v101, v100, v101
    v_lshlrev_b32 v100, 16, v101
    v_and_b32 v101, 0xffff0000, v101
    v_cvt_pk_bf16_f32 v103, v102, v103
    v_lshlrev_b32 v102, 16, v103
    v_and_b32 v103, 0xffff0000, v103
    v_mul_f32 v72, v72, v25
    v_mul_f32 v73, v73, v25
    v_mul_f32 v74, v74, v25
    v_mul_f32 v75, v75, v25
    v_mul_f32 v76, v76, v25
    v_mul_f32 v77, v77, v25
    v_mul_f32 v78, v78, v25
    v_mul_f32 v79, v79, v25
    v_mul_f32 v80, v80, v25
    v_mul_f32 v81, v81, v25
    v_mul_f32 v82, v82, v25
    v_mul_f32 v83, v83, v25
    v_mul_f32 v84, v84, v25
    v_mul_f32 v85, v85, v25
    v_mul_f32 v86, v86, v25
    v_mul_f32 v87, v87, v25
    v_mul_f32 v88, v88, v25
    v_mul_f32 v89, v89, v25
    v_mul_f32 v90, v90, v25
    v_mul_f32 v91, v91, v25
    v_mul_f32 v92, v92, v25
    v_mul_f32 v93, v93, v25
    v_mul_f32 v94, v94, v25
    v_mul_f32 v95, v95, v25
    v_mul_f32 v96, v96, v25
    v_mul_f32 v97, v97, v25
    v_mul_f32 v98, v98, v25
    v_mul_f32 v99, v99, v25
    v_mul_f32 v100, v100, v25
    v_mul_f32 v101, v101, v25
    v_mul_f32 v102, v102, v25
    v_mul_f32 v103, v103, v25
    v_cvt_pk_bf16_f32 v104, v72, v73
    v_cvt_pk_bf16_f32 v105, v74, v75
    v_cvt_pk_bf16_f32 v106, v76, v77
    v_cvt_pk_bf16_f32 v107, v78, v79
    v_cvt_pk_bf16_f32 v108, v80, v81
    v_cvt_pk_bf16_f32 v109, v82, v83
    v_cvt_pk_bf16_f32 v110, v84, v85
    v_cvt_pk_bf16_f32 v111, v86, v87
    v_cvt_pk_bf16_f32 v112, v88, v89
    v_cvt_pk_bf16_f32 v113, v90, v91
    v_cvt_pk_bf16_f32 v114, v92, v93
    v_cvt_pk_bf16_f32 v115, v94, v95
    v_cvt_pk_bf16_f32 v116, v96, v97
    v_cvt_pk_bf16_f32 v117, v98, v99
    v_cvt_pk_bf16_f32 v118, v100, v101
    v_cvt_pk_bf16_f32 v119, v102, v103
    v_and_b32 v6, 0x1f0, v2
    s_lshl_b32 s73, s34, 9
    s_add_u32 s73, s73, 4096
    v_mov_b32 v40, v104
    v_mov_b32 v41, v105
    v_mov_b32 v42, v106
    v_mov_b32 v43, v107
    s_cmp_eq_u32 s37, 1
    s_cselect_b64 vcc, -1, 0
    v_cndmask_b32 v40, v40, v108, vcc
    v_cndmask_b32 v41, v41, v109, vcc
    v_cndmask_b32 v42, v42, v110, vcc
    v_cndmask_b32 v43, v43, v111, vcc
    s_cmp_eq_u32 s37, 2
    s_cselect_b64 vcc, -1, 0
    v_cndmask_b32 v40, v40, v112, vcc
    v_cndmask_b32 v41, v41, v113, vcc
    v_cndmask_b32 v42, v42, v114, vcc
    v_cndmask_b32 v43, v43, v115, vcc
    s_cmp_eq_u32 s37, 3
    s_cselect_b64 vcc, -1, 0
    v_cndmask_b32 v40, v40, v116, vcc
    v_cndmask_b32 v41, v41, v117, vcc
    v_cndmask_b32 v42, v42, v118, vcc
    v_cndmask_b32 v43, v43, v119, vcc
    s_mov_b32 vcc_lo, 0xf000f
    s_mov_b32 vcc_hi, 0xf000f
    v_cndmask_b32 v8, 0, v40, vcc
    v_cndmask_b32 v9, 0, v41, vcc
    v_cndmask_b32 v10, 0, v42, vcc
    v_cndmask_b32 v11, 0, v43, vcc
    s_mov_b32 vcc_lo, 0xf000f0
    s_mov_b32 vcc_hi, 0xf000f0
    v_cndmask_b32 v12, 0, v40, vcc
    v_cndmask_b32 v13, 0, v41, vcc
    v_cndmask_b32 v14, 0, v42, vcc
    v_cndmask_b32 v15, 0, v43, vcc
    s_mov_b32 vcc_lo, 0xf000f00
    s_mov_b32 vcc_hi, 0xf000f00
    v_cndmask_b32 v16, 0, v40, vcc
    v_cndmask_b32 v17, 0, v41, vcc
    v_cndmask_b32 v18, 0, v42, vcc
    v_cndmask_b32 v19, 0, v43, vcc
    s_mov_b32 vcc_lo, 0xf000f000
    s_mov_b32 vcc_hi, 0xf000f000
    v_cndmask_b32 v20, 0, v40, vcc
    v_cndmask_b32 v21, 0, v41, vcc
    v_cndmask_b32 v22, 0, v42, vcc
    v_cndmask_b32 v23, 0, v43, vcc
    v_mov_b32 v26, 0
    s_mov_b32 s72, 131072
    s_nop 0
L_tg:
    ds_read_b64 v[68:69], v26 offset:264
    s_waitcnt lgkmcnt(0)
    v_cmp_eq_u32 vcc, 0, v69
    s_nop 0
    s_cbranch_vccz L_tgd
    s_sleep 2
    s_sub_u32 s72, s72, 1
    s_cbranch_scc0 L_tg
L_tgd:
    v_readfirstlane_b32 s5, v68
    s_waitcnt vmcnt(0)
    buffer_load_dwordx2 v[36:37], v6, s[44:47], s73 offen nt
    s_and_b32 s5, s5, 0xff
    s_getreg_b32 s7, hwreg(HW_REG_XCC_ID)
    s_and_b32 s7, s7, 15
    s_lshl_b32 s7, s7, 8
    s_or_b32 s7, s7, s5
    ds_read_b64_tr_b16 v[128:129], v32 offset:4096
    ds_read_b64_tr_b16 v[130:131], v32 offset:4608
    ds_read_b64_tr_b16 v[132:133], v32 offset:4104
    ds_read_b64_tr_b16 v[134:135], v32 offset:4616
    ds_read_b64_tr_b16 v[136:137], v32 offset:4112
    ds_read_b64_tr_b16 v[138:139], v32 offset:4624
    ds_read_b64_tr_b16 v[140:141], v32 offset:4120
    ds_read_b64_tr_b16 v[142:143], v32 offset:4632
    ds_read_b64_tr_b16 v[144:145], v32 offset:8192
    ds_read_b64_tr_b16 v[146:147], v32 offset:8704
    ds_read_b64_tr_b16 v[148:149], v32 offset:8200
    ds_read_b64_tr_b16 v[150:151], v32 offset:8712
    ds_read_b64_tr_b16 v[152:153], v32 offset:8208
    ds_read_b64_tr_b16 v[154:155], v32 offset:8720
    ds_read_b64_tr_b16 v[156:157], v32 offset:8216
    ds_read_b64_tr_b16 v[158:159], v32 offset:8728
    ds_read_b64_tr_b16 v[160:161], v32 offset:12288
    ds_read_b64_tr_b16 v[162:163], v32 offset:12800
    ds_read_b64_tr_b16 v[164:165], v32 offset:12296
    ds_read_b64_tr_b16 v[166:167], v32 offset:12808
    ds_read_b64_tr_b16 v[168:169], v32 offset:12304
    ds_read_b64_tr_b16 v[170:171], v32 offset:12816
    ds_read_b64_tr_b16 v[172:173], v32 offset:12312
    ds_read_b64_tr_b16 v[174:175], v32 offset:12824
    ds_read_b64_tr_b16 v[176:177], v32 offset:16384
    ds_read_b64_tr_b16 v[178:179], v32 offset:16896
    ds_read_b64_tr_b16 v[180:181], v32 offset:16392
    ds_read_b64_tr_b16 v[182:183], v32 offset:16904
    ds_read_b64_tr_b16 v[184:185], v32 offset:16400
    ds_read_b64_tr_b16 v[186:187], v32 offset:16912
    ds_read_b64_tr_b16 v[188:189], v32 offset:16408
    ds_read_b64_tr_b16 v[190:191], v32 offset:16920
    s_waitcnt lgkmcnt(0)
    v_mfma_f32_16x16x32_bf16 v[52:55], v[8:11], v[128:131], 0
    v_mfma_f32_16x16x32_bf16 v[56:59], v[8:11], v[132:135], 0
    v_mfma_f32_16x16x32_bf16 v[60:63], v[8:11], v[136:139], 0
    v_mfma_f32_16x16x32_bf16 v[64:67], v[8:11], v[140:143], 0
    v_mfma_f32_16x16x32_bf16 v[52:55], v[12:15], v[144:147], v[52:55]
    v_mfma_f32_16x16x32_bf16 v[56:59], v[12:15], v[148:151], v[56:59]
    v_mfma_f32_16x16x32_bf16 v[60:63], v[12:15], v[152:155], v[60:63]
    v_mfma_f32_16x16x32_bf16 v[64:67], v[12:15], v[156:159], v[64:67]
    v_mfma_f32_16x16x32_bf16 v[52:55], v[16:19], v[160:163], v[52:55]
    v_mfma_f32_16x16x32_bf16 v[56:59], v[16:19], v[164:167], v[56:59]
    v_mfma_f32_16x16x32_bf16 v[60:63], v[16:19], v[168:171], v[60:63]
    v_mfma_f32_16x16x32_bf16 v[64:67], v[16:19], v[172:175], v[64:67]
    v_mfma_f32_16x16x32_bf16 v[52:55], v[20:23], v[176:179], v[52:55]
    v_mfma_f32_16x16x32_bf16 v[56:59], v[20:23], v[180:183], v[56:59]
    v_mfma_f32_16x16x32_bf16 v[60:63], v[20:23], v[184:187], v[60:63]
    v_mfma_f32_16x16x32_bf16 v[64:67], v[20:23], v[188:191], v[64:67]
    s_nop 4
    v_permlane32_swap_b32 v52, v54
    v_permlane32_swap_b32 v53, v55
    v_permlane32_swap_b32 v56, v58
    v_permlane32_swap_b32 v57, v59
    v_permlane32_swap_b32 v60, v62
    v_permlane32_swap_b32 v61, v63
    v_permlane32_swap_b32 v64, v66
    v_permlane32_swap_b32 v65, v67
    v_add_f32 v52, v52, v54
    v_add_f32 v53, v53, v55
    v_add_f32 v56, v56, v58
    v_add_f32 v57, v57, v59
    v_add_f32 v60, v60, v62
    v_add_f32 v61, v61, v63
    v_add_f32 v64, v64, v66
    v_add_f32 v65, v65, v67
    v_permlane16_swap_b32 v52, v53
    v_permlane16_swap_b32 v56, v57
    v_permlane16_swap_b32 v60, v61
    v_permlane16_swap_b32 v64, v65
    v_add_f32 v52, v52, v53
    v_add_f32 v56, v56, v57
    v_add_f32 v60, v60, v61
    v_add_f32 v64, v64, v65
    v_add_u32 v68, 0x80, v52
    v_bfi_b32 v68, v29, s5, v68
    v_add_u32 v69, 0x80, v56
    v_bfi_b32 v69, v29, s5, v69
    v_add_u32 v70, 0x80, v60
    v_bfi_b32 v70, v29, s5, v70
    v_add_u32 v71, 0x80, v64
    v_bfi_b32 v71, v29, s5, v71
    s_mov_b32 s72, 8
    s_mov_b32 s74, 1
L_c0:
    s_waitcnt vmcnt(0)
    v_xor_b32 v36, s7, v36
    v_bitop3_b32 v36, v37, v36, s7 bitop3:0xde
    v_cmp_ne_u32 vcc, 0, v36
    s_nop 0
    s_cbranch_vccz L_c0d
    v_and_b32 v37, 0xfffff0ff, v36
    v_cmp_eq_u32 s[70:71], 0, v37
    s_and_b64 vcc, vcc, s[70:71]
    s_nop 2
    s_cbranch_scc1 L_c0f
    s_sleep 8
    buffer_load_dwordx2 v[36:37], v6, s[44:47], s73 offen nt
    s_sub_u32 s72, s72, 1
    s_cbranch_scc0 L_c0
    s_waitcnt vmcnt(0)
L_c0f:
    s_mov_b32 s74, 0
L_c0d:
    s_cmp_eq_u32 s74, 0
    s_cbranch_scc1 L_st1
    buffer_store_dwordx4 v[68:71], v2, s[44:47], s57 offen
    s_nop 0
    s_branch L_st1d
L_st1:
    buffer_store_dwordx4 v[68:71], v2, s[44:47], s57 offen sc1
    s_nop 1
L_st1d:
    s_mov_b32 s66, -1
    s_mov_b32 m0, 4096
    s_cmp_eq_u32 s34, 7
    s_cbranch_scc1 L_tr
    s_cmp_ge_u32 s37, 2
    s_cbranch_scc1 L_m2
    s_lshl_b32 s62, s34, 4
    s_add_u32 s62, s62, s35
    s_and_b32 s63, s62, 3
    s_mul_i32 s60, s63, 458752
    s_lshr_b32 s39, s62, 2
    s_lshl_b32 s39, s39, 7
    s_add_u32 s60, s60, s39
    s_mov_b32 s61, 28672
    s_mov_b32 s39, 3584
    v_mad_u32_u24 v7, v30, s39, v31
    s_mov_b32 s48, s20
    s_mov_b32 s49, s21
    s_mov_b32 s50, 0x1c0000
    s_mov_b32 s51, 0x20000
    buffer_load_dwordx4 v7, s[48:51], s60 offen nt lds
    s_add_u32 s60, s60, s61
    s_add_u32 m0, m0, 0x400
    s_nop 0
    buffer_load_dwordx4 v7, s[48:51], s60 offen nt lds
    s_add_u32 s60, s60, s61
    s_add_u32 m0, m0, 0x400
    s_nop 0
    buffer_load_dwordx4 v7, s[48:51], s60 offen nt lds
    s_add_u32 s60, s60, s61
    s_add_u32 m0, m0, 0x400
    s_nop 0
    buffer_load_dwordx4 v7, s[48:51], s60 offen nt lds
    s_add_u32 s60, s60, s61
    s_add_u32 m0, m0, 0x400
    s_nop 0
    buffer_load_dwordx4 v7, s[48:51], s60 offen nt lds
    s_add_u32 s60, s60, s61
    s_add_u32 m0, m0, 0x400
    s_nop 0
    buffer_load_dwordx4 v7, s[48:51], s60 offen nt lds
    s_add_u32 s60, s60, s61
    s_add_u32 m0, m0, 0x400
    s_nop 0
    buffer_load_dwordx4 v7, s[48:51], s60 offen nt lds
    s_add_u32 s60, s60, s61
    s_add_u32 m0, m0, 0x400
    s_nop 0
    buffer_load_dwordx4 v7, s[48:51], s60 offen nt lds
    s_add_u32 s60, s60, s61
    s_add_u32 m0, m0, 0x400
    v_lshlrev_b32 v72, 16, v104
    v_and_b32 v73, 0xffff0000, v104
    v_lshlrev_b32 v74, 16, v105
    v_and_b32 v75, 0xffff0000, v105
    v_lshlrev_b32 v76, 16, v106
    v_and_b32 v77, 0xffff0000, v106
    v_lshlrev_b32 v78, 16, v107
    v_and_b32 v79, 0xffff0000, v107
    v_lshlrev_b32 v80, 16, v108
    v_and_b32 v81, 0xffff0000, v108
    v_lshlrev_b32 v82, 16, v109
    v_and_b32 v83, 0xffff0000, v109
    v_lshlrev_b32 v84, 16, v110
    v_and_b32 v85, 0xffff0000, v110
    v_lshlrev_b32 v86, 16, v111
    v_and_b32 v87, 0xffff0000, v111
    v_lshlrev_b32 v88, 16, v112
    v_and_b32 v89, 0xffff0000, v112
    v_lshlrev_b32 v90, 16, v113
    v_and_b32 v91, 0xffff0000, v113
    v_lshlrev_b32 v92, 16, v114
    v_and_b32 v93, 0xffff0000, v114
    v_lshlrev_b32 v94, 16, v115
    v_and_b32 v95, 0xffff0000, v115
    v_lshlrev_b32 v96, 16, v116
    v_and_b32 v97, 0xffff0000, v116
    v_lshlrev_b32 v98, 16, v117
    v_and_b32 v99, 0xffff0000, v117
    v_lshlrev_b32 v100, 16, v118
    v_and_b32 v101, 0xffff0000, v118
    v_lshlrev_b32 v102, 16, v119
    v_and_b32 v103, 0xffff0000, v119
    v_add_f32 v24, v72, v73
    v_add_f32 v27, v74, v75
    v_add_f32 v24, v24, v76
    v_add_f32 v27, v27, v77
    v_add_f32 v24, v24, v78
    v_add_f32 v27, v27, v79
    v_add_f32 v24, v24, v80
    v_add_f32 v27, v27, v81
    v_add_f32 v24, v24, v82
    v_add_f32 v27, v27, v83
    v_add_f32 v24, v24, v84
    v_add_f32 v27, v27, v85
    v_add_f32 v24, v24, v86
    v_add_f32 v27, v27, v87
    v_add_f32 v24, v24, v88
    v_add_f32 v27, v27, v89
    v_add_f32 v24, v24, v90
    v_add_f32 v27, v27, v91
    v_add_f32 v24, v24, v92
    v_add_f32 v27, v27, v93
    v_add_f32 v24, v24, v94
    v_add_f32 v27, v27, v95
    v_add_f32 v24, v24, v96
    v_add_f32 v27, v27, v97
    v_add_f32 v24, v24, v98
    v_add_f32 v27, v27, v99
    v_add_f32 v24, v24, v100
    v_add_f32 v27, v27, v101
    v_add_f32 v24, v24, v102
    v_add_f32 v27, v27, v103
    v_add_f32 v24, v24, v27
    s_nop 1
    v_add_f32_dpp v24, v24, v24 row_ror:4 row_mask:0xf bank_mask:0xf
    s_nop 1
    v_add_f32_dpp v24, v24, v24 row_ror:8 row_mask:0xf bank_mask:0xf
    v_mov_b32 v26, v24
    s_nop 1
    v_permlane16_swap_b32 v24, v26
    v_add_f32 v24, v24, v26
    v_mov_b32 v26, v24
    s_nop 1
    v_permlane32_swap_b32 v24, v26
    v_add_f32 v24, v24, v26
    v_mul_f32 v24, 0x3b000000, v24
    v_sub_f32 v27, v72, v24
    v_sub_f32 v28, v73, v24
    v_mul_f32 v25, v27, v27
    v_mul_f32 v26, v28, v28
    v_sub_f32 v27, v74, v24
    v_sub_f32 v28, v75, v24
    v_fmac_f32 v25, v27, v27
    v_fmac_f32 v26, v28, v28
    v_sub_f32 v27, v76, v24
    v_sub_f32 v28, v77, v24
    v_fmac_f32 v25, v27, v27
    v_fmac_f32 v26, v28, v28
    v_sub_f32 v27, v78, v24
    v_sub_f32 v28, v79, v24
    v_fmac_f32 v25, v27, v27
    v_fmac_f32 v26, v28, v28
    v_sub_f32 v27, v80, v24
    v_sub_f32 v28, v81, v24
    v_fmac_f32 v25, v27, v27
    v_fmac_f32 v26, v28, v28
    v_sub_f32 v27, v82, v24
    v_sub_f32 v28, v83, v24
    v_fmac_f32 v25, v27, v27
    v_fmac_f32 v26, v28, v28
    v_sub_f32 v27, v84, v24
    v_sub_f32 v28, v85, v24
    v_fmac_f32 v25, v27, v27
    v_fmac_f32 v26, v28, v28
    v_sub_f32 v27, v86, v24
    v_sub_f32 v28, v87, v24
    v_fmac_f32 v25, v27, v27
    v_fmac_f32 v26, v28, v28
    v_sub_f32 v27, v88, v24
    v_sub_f32 v28, v89, v24
    v_fmac_f32 v25, v27, v27
    v_fmac_f32 v26, v28, v28
    v_sub_f32 v27, v90, v24
    v_sub_f32 v28, v91, v24
    v_fmac_f32 v25, v27, v27
    v_fmac_f32 v26, v28, v28
    v_sub_f32 v27, v92, v24
    v_sub_f32 v28, v93, v24
    v_fmac_f32 v25, v27, v27
    v_fmac_f32 v26, v28, v28
    v_sub_f32 v27, v94, v24
    v_sub_f32 v28, v95, v24
    v_fmac_f32 v25, v27, v27
    v_fmac_f32 v26, v28, v28
    v_sub_f32 v27, v96, v24
    v_sub_f32 v28, v97, v24
    v_fmac_f32 v25, v27, v27
    v_fmac_f32 v26, v28, v28
    v_sub_f32 v27, v98, v24
    v_sub_f32 v28, v99, v24
    v_fmac_f32 v25, v27, v27
    v_fmac_f32 v26, v28, v28
    v_sub_f32 v27, v100, v24
    v_sub_f32 v28, v101, v24
    v_fmac_f32 v25, v27, v27
    v_fmac_f32 v26, v28, v28
    v_sub_f32 v27, v102, v24
    v_sub_f32 v28, v103, v24
    v_fmac_f32 v25, v27, v27
    v_fmac_f32 v26, v28, v28
    v_add_f32 v25, v25, v26
    s_nop 1
    v_add_f32_dpp v25, v25, v25 row_ror:4 row_mask:0xf bank_mask:0xf
    s_nop 1
    v_add_f32_dpp v25, v25, v25 row_ror:8 row_mask:0xf bank_mask:0xf
    v_mov_b32 v26, v25
    s_nop 1
    v_permlane16_swap_b32 v25, v26
    v_add_f32 v25, v25, v26
    v_mov_b32 v26, v25
    s_nop 1
    v_permlane32_swap_b32 v25, v26
    v_add_f32 v25, v25, v26
    v_mul_f32 v25, 0x3b000000, v25
    v_cvt_pk_bf16_f32 v25, v24, v25
    v_lshlrev_b32 v24, 16, v25
    v_and_b32 v25, 0xffff0000, v25
    v_add_f32 v25, 0x3727c5ac, v25
    v_cvt_pk_bf16_f32 v25, v25, v25
    v_and_b32 v25, 0xffff0000, v25
    v_sqrt_f32 v25, v25
    s_nop 0
    v_cvt_pk_bf16_f32 v25, v25, v25
    v_and_b32 v25, 0xffff0000, v25
    v_rcp_f32 v25, v25
    v_mov_b32 v40, v104
    v_mov_b32 v41, v105
    v_mov_b32 v42, v106
    v_mov_b32 v43, v107
    s_cmp_eq_u32 s63, 1
    s_cselect_b64 vcc, -1, 0
    v_cndmask_b32 v40, v40, v108, vcc
    v_cndmask_b32 v41, v41, v109, vcc
    v_cndmask_b32 v42, v42, v110, vcc
    v_cndmask_b32 v43, v43, v111, vcc
    s_cmp_eq_u32 s63, 2
    s_cselect_b64 vcc, -1, 0
    v_cndmask_b32 v40, v40, v112, vcc
    v_cndmask_b32 v41, v41, v113, vcc
    v_cndmask_b32 v42, v42, v114, vcc
    v_cndmask_b32 v43, v43, v115, vcc
    s_cmp_eq_u32 s63, 3
    s_cselect_b64 vcc, -1, 0
    v_cndmask_b32 v40, v40, v116, vcc
    v_cndmask_b32 v41, v41, v117, vcc
    v_cndmask_b32 v42, v42, v118, vcc
    v_cndmask_b32 v43, v43, v119, vcc
    v_lshlrev_b32 v72, 16, v40
    v_and_b32 v73, 0xffff0000, v40
    v_lshlrev_b32 v74, 16, v41
    v_and_b32 v75, 0xffff0000, v41
    v_lshlrev_b32 v76, 16, v42
    v_and_b32 v77, 0xffff0000, v42
    v_lshlrev_b32 v78, 16, v43
    v_and_b32 v79, 0xffff0000, v43
    v_sub_f32 v72, v72, v24
    v_sub_f32 v73, v73, v24
    v_sub_f32 v74, v74, v24
    v_sub_f32 v75, v75, v24
    v_sub_f32 v76, v76, v24
    v_sub_f32 v77, v77, v24
    v_sub_f32 v78, v78, v24
    v_sub_f32 v79, v79, v24
    v_cvt_pk_bf16_f32 v73, v72, v73
    v_lshlrev_b32 v72, 16, v73
    v_and_b32 v73, 0xffff0000, v73
    v_cvt_pk_bf16_f32 v75, v74, v75
    v_lshlrev_b32 v74, 16, v75
    v_and_b32 v75, 0xffff0000, v75
    v_cvt_pk_bf16_f32 v77, v76, v77
    v_lshlrev_b32 v76, 16, v77
    v_and_b32 v77, 0xffff0000, v77
    v_cvt_pk_bf16_f32 v79, v78, v79
    v_lshlrev_b32 v78, 16, v79
    v_and_b32 v79, 0xffff0000, v79
    v_mul_f32 v72, v72, v25
    v_mul_f32 v73, v73, v25
    v_mul_f32 v74, v74, v25
    v_mul_f32 v75, v75, v25
    v_mul_f32 v76, v76, v25
    v_mul_f32 v77, v77, v25
    v_mul_f32 v78, v78, v25
    v_mul_f32 v79, v79, v25
    v_cvt_pk_bf16_f32 v40, v72, v73
    v_cvt_pk_bf16_f32 v41, v74, v75
    v_cvt_pk_bf16_f32 v42, v76, v77
    v_cvt_pk_bf16_f32 v43, v78, v79
    s_mov_b32 vcc_lo, 0xf000f
    s_mov_b32 vcc_hi, 0xf000f
    v_cndmask_b32 v8, 0, v40, vcc
    v_cndmask_b32 v9, 0, v41, vcc
    v_cndmask_b32 v10, 0, v42, vcc
    v_cndmask_b32 v11, 0, v43, vcc
    s_mov_b32 vcc_lo, 0xf000f0
    s_mov_b32 vcc_hi, 0xf000f0
    v_cndmask_b32 v12, 0, v40, vcc
    v_cndmask_b32 v13, 0, v41, vcc
    v_cndmask_b32 v14, 0, v42, vcc
    v_cndmask_b32 v15, 0, v43, vcc
    s_mov_b32 vcc_lo, 0xf000f00
    s_mov_b32 vcc_hi, 0xf000f00
    v_cndmask_b32 v16, 0, v40, vcc
    v_cndmask_b32 v17, 0, v41, vcc
    v_cndmask_b32 v18, 0, v42, vcc
    v_cndmask_b32 v19, 0, v43, vcc
    s_mov_b32 vcc_lo, 0xf000f000
    s_mov_b32 vcc_hi, 0xf000f000
    v_cndmask_b32 v20, 0, v40, vcc
    v_cndmask_b32 v21, 0, v41, vcc
    v_cndmask_b32 v22, 0, v42, vcc
    v_cndmask_b32 v23, 0, v43, vcc
    s_mov_b32 s64, 8
    s_nop 0
L_t1:
    s_waitcnt vmcnt(7)
    buffer_load_dwordx4 v7, s[48:51], s60 offen nt lds
    s_add_u32 s60, s60, s61
    s_add_u32 m0, m0, 0x400
    s_sub_u32 s64, s64, 1
    s_cmp_lg_u32 s64, 0
    s_cbranch_scc1 L_t1
    s_mul_i32 s62, s62, 1024
    s_add_u32 s62, s62, 262144
    s_waitcnt vmcnt(0)
    ds_read_b64_tr_b16 v[128:129], v32 offset:4096
    ds_read_b64_tr_b16 v[130:131], v32 offset:4608
    ds_read_b64_tr_b16 v[132:133], v32 offset:4104
    ds_read_b64_tr_b16 v[134:135], v32 offset:4616
    ds_read_b64_tr_b16 v[136:137], v32 offset:4112
    ds_read_b64_tr_b16 v[138:139], v32 offset:4624
    ds_read_b64_tr_b16 v[140:141], v32 offset:4120
    ds_read_b64_tr_b16 v[142:143], v32 offset:4632
    ds_read_b64_tr_b16 v[144:145], v32 offset:8192
    ds_read_b64_tr_b16 v[146:147], v32 offset:8704
    ds_read_b64_tr_b16 v[148:149], v32 offset:8200
    ds_read_b64_tr_b16 v[150:151], v32 offset:8712
    ds_read_b64_tr_b16 v[152:153], v32 offset:8208
    ds_read_b64_tr_b16 v[154:155], v32 offset:8720
    ds_read_b64_tr_b16 v[156:157], v32 offset:8216
    ds_read_b64_tr_b16 v[158:159], v32 offset:8728
    ds_read_b64_tr_b16 v[160:161], v32 offset:12288
    ds_read_b64_tr_b16 v[162:163], v32 offset:12800
    ds_read_b64_tr_b16 v[164:165], v32 offset:12296
    ds_read_b64_tr_b16 v[166:167], v32 offset:12808
    ds_read_b64_tr_b16 v[168:169], v32 offset:12304
    ds_read_b64_tr_b16 v[170:171], v32 offset:12816
    ds_read_b64_tr_b16 v[172:173], v32 offset:12312
    ds_read_b64_tr_b16 v[174:175], v32 offset:12824
    ds_read_b64_tr_b16 v[176:177], v32 offset:16384
    ds_read_b64_tr_b16 v[178:179], v32 offset:16896
    ds_read_b64_tr_b16 v[180:181], v32 offset:16392
    ds_read_b64_tr_b16 v[182:183], v32 offset:16904
    ds_read_b64_tr_b16 v[184:185], v32 offset:16400
    ds_read_b64_tr_b16 v[186:187], v32 offset:16912
    ds_read_b64_tr_b16 v[188:189], v32 offset:16408
    ds_read_b64_tr_b16 v[190:191], v32 offset:16920
    s_waitcnt lgkmcnt(0)
    v_mfma_f32_16x16x32_bf16 v[52:55], v[8:11], v[128:131], 0
    v_mfma_f32_16x16x32_bf16 v[56:59], v[8:11], v[132:135], 0
    v_mfma_f32_16x16x32_bf16 v[60:63], v[8:11], v[136:139], 0
    v_mfma_f32_16x16x32_bf16 v[64:67], v[8:11], v[140:143], 0
    v_mfma_f32_16x16x32_bf16 v[52:55], v[12:15], v[144:147], v[52:55]
    v_mfma_f32_16x16x32_bf16 v[56:59], v[12:15], v[148:151], v[56:59]
    v_mfma_f32_16x16x32_bf16 v[60:63], v[12:15], v[152:155], v[60:63]
    v_mfma_f32_16x16x32_bf16 v[64:67], v[12:15], v[156:159], v[64:67]
    v_mfma_f32_16x16x32_bf16 v[52:55], v[16:19], v[160:163], v[52:55]
    v_mfma_f32_16x16x32_bf16 v[56:59], v[16:19], v[164:167], v[56:59]
    v_mfma_f32_16x16x32_bf16 v[60:63], v[16:19], v[168:171], v[60:63]
    v_mfma_f32_16x16x32_bf16 v[64:67], v[16:19], v[172:175], v[64:67]
    v_mfma_f32_16x16x32_bf16 v[52:55], v[20:23], v[176:179], v[52:55]
    v_mfma_f32_16x16x32_bf16 v[56:59], v[20:23], v[180:183], v[56:59]
    v_mfma_f32_16x16x32_bf16 v[60:63], v[20:23], v[184:187], v[60:63]
    v_mfma_f32_16x16x32_bf16 v[64:67], v[20:23], v[188:191], v[64:67]
    s_nop 4
    v_permlane32_swap_b32 v52, v54
    v_permlane32_swap_b32 v53, v55
    v_permlane32_swap_b32 v56, v58
    v_permlane32_swap_b32 v57, v59
    v_permlane32_swap_b32 v60, v62
    v_permlane32_swap_b32 v61, v63
    v_permlane32_swap_b32 v64, v66
    v_permlane32_swap_b32 v65, v67
    v_add_f32 v52, v52, v54
    v_add_f32 v53, v53, v55
    v_add_f32 v56, v56, v58
    v_add_f32 v57, v57, v59
    v_add_f32 v60, v60, v62
    v_add_f32 v61, v61, v63
    v_add_f32 v64, v64, v66
    v_add_f32 v65, v65, v67
    v_permlane16_swap_b32 v52, v53
    v_permlane16_swap_b32 v56, v57
    v_permlane16_swap_b32 v60, v61
    v_permlane16_swap_b32 v64, v65
    v_add_f32 v52, v52, v53
    v_add_f32 v56, v56, v57
    v_add_f32 v60, v60, v61
    v_add_f32 v64, v64, v65
    v_add_u32 v68, 0x80, v52
    v_bfi_b32 v68, v29, s5, v68
    v_add_u32 v69, 0x80, v56
    v_bfi_b32 v69, v29, s5, v69
    v_add_u32 v70, 0x80, v60
    v_bfi_b32 v70, v29, s5, v70
    v_add_u32 v71, 0x80, v64
    v_bfi_b32 v71, v29, s5, v71
    s_cmp_eq_u32 s74, 0
    s_cbranch_scc1 L_st2
    buffer_store_dwordx4 v[68:71], v2, s[44:47], s62 offen
    s_nop 0
    s_branch L_st2d
L_st2:
    buffer_store_dwordx4 v[68:71], v2, s[44:47], s62 offen sc1
    s_nop 1
L_st2d:
    s_branch L_tr
L_m2:
    s_mov_b32 s48, s24
    s_mov_b32 s49, s25
    s_mov_b32 s50, 0x1c0000
    s_mov_b32 s51, 0x20000
    s_mov_b32 s68, s22
    s_mov_b32 s69, s23
    s_mov_b32 s70, 0xe00
    s_mov_b32 s71, 0x20000
    s_lshl_b32 s62, s34, 1
    s_and_b32 s39, s37, 1
    s_add_u32 s62, s62, s39
    s_add_u32 s63, s35, 4
    s_and_b32 s63, s63, 7
    s_lshl_b32 s60, s62, 17
    s_lshl_b32 s39, s63, 7
    s_add_u32 s60, s60, s39
    s_mov_b32 s61, 0x2000
    v_lshl_add_u32 v7, v30, 10, v31
    v_lshrrev_b32 v5, 1, v4
    v_and_b32 v6, 1, v4
    v_lshlrev_b32 v6, 1, v6
    v_lshl_add_u32 v6, v5, 4, v6
    v_lshl_add_u32 v32, v34, 2, v6
    v_lshlrev_b32 v32, 7, v32
    v_lshl_add_u32 v32, v33, 5, v32
    v_lshl_add_u32 v6, v34, 5, v6
    v_lshlrev_b32 v6, 1, v6
    s_lshl_b32 s39, s62, 8
    buffer_load_dword v36, v6, s[68:71], s39 offen offset:0
    buffer_load_dword v37, v6, s[68:71], s39 offen offset:8
    buffer_load_dword v38, v6, s[68:71], s39 offen offset:16
    buffer_load_dword v39, v6, s[68:71], s39 offen offset:24
    s_mov_b32 s64, 16
L_t2:
    s_waitcnt vmcnt(7)
    buffer_load_dwordx4 v7, s[48:51], s60 offen nt lds
    s_add_u32 s60, s60, s61
    s_add_u32 m0, m0, 0x400
    s_sub_u32 s64, s64, 1
    s_cmp_lg_u32 s64, 0
    s_cbranch_scc1 L_t2
    s_mul_i32 s56, s62, 8192
    s_add_u32 s56, s56, 262144
    s_add_u32 s57, s56, 1024
    s_add_u32 s58, s56, 2048
    s_add_u32 s59, s56, 3072
    s_mov_b32 s39, 4096
    v_lshlrev_b32 v7, 8, v33
    v_lshl_add_u32 v7, v4, 5, v7
    v_bfe_u32 v5, v1, 2, 1
    v_lshl_add_u32 v7, v5, 7, v7
    v_bfe_u32 v5, v1, 3, 1
    v_mad_u32_u24 v5, v5, s39, v7
    s_lshl_b32 s62, s62, 3
    s_add_u32 s62, s62, s63
    s_mul_i32 s62, s62, 1024
    s_lshr_b32 s39, s62, 1
    s_xor_b32 s39, s39, s62
    s_and_b32 s39, s39, 0x1000
    s_mul_i32 s39, s39, 3
    s_xor_b32 s62, s62, s39
    s_add_u32 s62, s62, 524288
    s_waitcnt vmcnt(0)
    ds_read_b64_tr_b16 v[128:129], v32 offset:4096
    ds_read_b64_tr_b16 v[130:131], v32 offset:4224
    ds_read_b64_tr_b16 v[132:133], v32 offset:4104
    ds_read_b64_tr_b16 v[134:135], v32 offset:4232
    ds_read_b64_tr_b16 v[136:137], v32 offset:4112
    ds_read_b64_tr_b16 v[138:139], v32 offset:4240
    ds_read_b64_tr_b16 v[140:141], v32 offset:4120
    ds_read_b64_tr_b16 v[142:143], v32 offset:4248
    ds_read_b64_tr_b16 v[144:145], v32 offset:8192
    ds_read_b64_tr_b16 v[146:147], v32 offset:8320
    ds_read_b64_tr_b16 v[148:149], v32 offset:8200
    ds_read_b64_tr_b16 v[150:151], v32 offset:8328
    ds_read_b64_tr_b16 v[152:153], v32 offset:8208
    ds_read_b64_tr_b16 v[154:155], v32 offset:8336
    ds_read_b64_tr_b16 v[156:157], v32 offset:8216
    ds_read_b64_tr_b16 v[158:159], v32 offset:8344
    ds_read_b64_tr_b16 v[160:161], v32 offset:12288
    ds_read_b64_tr_b16 v[162:163], v32 offset:12416
    ds_read_b64_tr_b16 v[164:165], v32 offset:12296
    ds_read_b64_tr_b16 v[166:167], v32 offset:12424
    ds_read_b64_tr_b16 v[168:169], v32 offset:12304
    ds_read_b64_tr_b16 v[170:171], v32 offset:12432
    ds_read_b64_tr_b16 v[172:173], v32 offset:12312
    ds_read_b64_tr_b16 v[174:175], v32 offset:12440
    ds_read_b64_tr_b16 v[176:177], v32 offset:16384
    ds_read_b64_tr_b16 v[178:179], v32 offset:16512
    ds_read_b64_tr_b16 v[180:181], v32 offset:16392
    ds_read_b64_tr_b16 v[182:183], v32 offset:16520
    ds_read_b64_tr_b16 v[184:185], v32 offset:16400
    ds_read_b64_tr_b16 v[186:187], v32 offset:16528
    ds_read_b64_tr_b16 v[188:189], v32 offset:16408
    ds_read_b64_tr_b16 v[190:191], v32 offset:16536
    s_waitcnt lgkmcnt(0)
    v_mov_b32 v26, 0
    s_mov_b32 s72, 131072
    s_nop 0
L_wm:
    ds_read_b32 v27, v26 offset:272
    s_waitcnt lgkmcnt(0)
    v_cmp_gt_u32 vcc, 56, v27
    s_nop 0
    s_cbranch_vccz L_wmd
    s_sleep 16
    s_sub_u32 s72, s72, 1
    s_cbranch_scc0 L_wm
L_wmd:
    s_mov_b32 s72, 131072
    buffer_load_dwordx4 v[72:75], v5, s[44:47], s56 offen offset:0 nt
    buffer_load_dwordx4 v[76:79], v5, s[44:47], s56 offen offset:16 nt
    buffer_load_dwordx4 v[80:83], v5, s[44:47], s57 offen offset:0 nt
    buffer_load_dwordx4 v[84:87], v5, s[44:47], s57 offen offset:16 nt
    buffer_load_dwordx4 v[88:91], v5, s[44:47], s58 offen offset:0 nt
    buffer_load_dwordx4 v[92:95], v5, s[44:47], s58 offen offset:16 nt
    buffer_load_dwordx4 v[96:99], v5, s[44:47], s59 offen offset:0 nt
    buffer_load_dwordx4 v[100:103], v5, s[44:47], s59 offen offset:16 nt
L_pl3:
    s_waitcnt vmcnt(0)
    v_xor_b32 v26, s5, v72
    v_xor_b32 v27, s5, v73
    v_bitop3_b32 v26, v74, v26, s5 bitop3:0xde
    v_bitop3_b32 v27, v75, v27, s5 bitop3:0xde
    v_bitop3_b32 v26, v76, v26, s5 bitop3:0xde
    v_bitop3_b32 v27, v77, v27, s5 bitop3:0xde
    v_bitop3_b32 v26, v78, v26, s5 bitop3:0xde
    v_bitop3_b32 v27, v79, v27, s5 bitop3:0xde
    v_bitop3_b32 v26, v80, v26, s5 bitop3:0xde
    v_bitop3_b32 v27, v81, v27, s5 bitop3:0xde
    v_bitop3_b32 v26, v82, v26, s5 bitop3:0xde
    v_bitop3_b32 v27, v83, v27, s5 bitop3:0xde
    v_bitop3_b32 v26, v84, v26, s5 bitop3:0xde
    v_bitop3_b32 v27, v85, v27, s5 bitop3:0xde
    v_bitop3_b32 v26, v86, v26, s5 bitop3:0xde
    v_bitop3_b32 v27, v87, v27, s5 bitop3:0xde
    v_bitop3_b32 v26, v88, v26, s5 bitop3:0xde
    v_bitop3_b32 v27, v89, v27, s5 bitop3:0xde
    v_bitop3_b32 v26, v90, v26, s5 bitop3:0xde
    v_bitop3_b32 v27, v91, v27, s5 bitop3:0xde
    v_bitop3_b32 v26, v92, v26, s5 bitop3:0xde
    v_bitop3_b32 v27, v93, v27, s5 bitop3:0xde
    v_bitop3_b32 v26, v94, v26, s5 bitop3:0xde
    v_bitop3_b32 v27, v95, v27, s5 bitop3:0xde
    v_bitop3_b32 v26, v96, v26, s5 bitop3:0xde
    v_bitop3_b32 v27, v97, v27, s5 bitop3:0xde
    v_bitop3_b32 v26, v98, v26, s5 bitop3:0xde
    v_bitop3_b32 v27, v99, v27, s5 bitop3:0xde
    v_bitop3_b32 v26, v100, v26, s5 bitop3:0xde
    v_bitop3_b32 v27, v101, v27, s5 bitop3:0xde
    v_bitop3_b32 v26, v102, v26, s5 bitop3:0xde
    v_bitop3_b32 v27, v103, v27, s5 bitop3:0xde
    v_or_b32 v26, v26, v27
    v_and_b32 v26, 0xff, v26
    v_cmp_ne_u32 vcc, 0, v26
    s_nop 0
    s_cbranch_vccz L_pl3d
    s_sleep 32
    s_mov_b64 exec, vcc
    buffer_load_dwordx4 v[72:75], v5, s[44:47], s56 offen offset:0 sc1
    buffer_load_dwordx4 v[76:79], v5, s[44:47], s56 offen offset:16 sc1
    buffer_load_dwordx4 v[80:83], v5, s[44:47], s57 offen offset:0 sc1
    buffer_load_dwordx4 v[84:87], v5, s[44:47], s57 offen offset:16 sc1
    buffer_load_dwordx4 v[88:91], v5, s[44:47], s58 offen offset:0 sc1
    buffer_load_dwordx4 v[92:95], v5, s[44:47], s58 offen offset:16 sc1
    buffer_load_dwordx4 v[96:99], v5, s[44:47], s59 offen offset:0 sc1
    buffer_load_dwordx4 v[100:103], v5, s[44:47], s59 offen offset:16 sc1
    s_mov_b64 exec, -1
    s_sub_u32 s72, s72, 1
    s_cbranch_scc0 L_pl3
    s_waitcnt vmcnt(0)
L_pl3d:
    v_and_b32 v72, 0xffffff00, v72
    v_and_b32 v73, 0xffffff00, v73
    v_and_b32 v74, 0xffffff00, v74
    v_and_b32 v75, 0xffffff00, v75
    v_and_b32 v76, 0xffffff00, v76
    v_and_b32 v77, 0xffffff00, v77
    v_and_b32 v78, 0xffffff00, v78
    v_and_b32 v79, 0xffffff00, v79
    v_and_b32 v80, 0xffffff00, v80
    v_and_b32 v81, 0xffffff00, v81
    v_and_b32 v82, 0xffffff00, v82
    v_and_b32 v83, 0xffffff00, v83
    v_and_b32 v84, 0xffffff00, v84
    v_and_b32 v85, 0xffffff00, v85
    v_and_b32 v86, 0xffffff00, v86
    v_and_b32 v87, 0xffffff00, v87
    v_and_b32 v88, 0xffffff00, v88
    v_and_b32 v89, 0xffffff00, v89
    v_and_b32 v90, 0xffffff00, v90
    v_and_b32 v91, 0xffffff00, v91
    v_and_b32 v92, 0xffffff00, v92
    v_and_b32 v93, 0xffffff00, v93
    v_and_b32 v94, 0xffffff00, v94
    v_and_b32 v95, 0xffffff00, v95
    v_and_b32 v96, 0xffffff00, v96
    v_and_b32 v97, 0xffffff00, v97
    v_and_b32 v98, 0xffffff00, v98
    v_and_b32 v99, 0xffffff00, v99
    v_and_b32 v100, 0xffffff00, v100
    v_and_b32 v101, 0xffffff00, v101
    v_and_b32 v102, 0xffffff00, v102
    v_and_b32 v103, 0xffffff00, v103
    v_add_f32 v72, v72, v88
    v_add_f32 v73, v73, v89
    v_add_f32 v74, v74, v90
    v_add_f32 v75, v75, v91
    v_add_f32 v76, v76, v92
    v_add_f32 v77, v77, v93
    v_add_f32 v78, v78, v94
    v_add_f32 v79, v79, v95
    v_add_f32 v80, v80, v96
    v_add_f32 v81, v81, v97
    v_add_f32 v82, v82, v98
    v_add_f32 v83, v83, v99
    v_add_f32 v84, v84, v100
    v_add_f32 v85, v85, v101
    v_add_f32 v86, v86, v102
    v_add_f32 v87, v87, v103
    v_add_f32 v72, v72, v80
    v_add_f32 v73, v73, v81
    v_add_f32 v74, v74, v82
    v_add_f32 v75, v75, v83
    v_add_f32 v76, v76, v84
    v_add_f32 v77, v77, v85
    v_add_f32 v78, v78, v86
    v_add_f32 v79, v79, v87
    v_cvt_pk_bf16_f32 v73, v72, v73
    v_lshlrev_b32 v72, 16, v73
    v_and_b32 v73, 0xffff0000, v73
    v_cvt_pk_bf16_f32 v75, v74, v75
    v_lshlrev_b32 v74, 16, v75
    v_and_b32 v75, 0xffff0000, v75
    v_cvt_pk_bf16_f32 v77, v76, v77
    v_lshlrev_b32 v76, 16, v77
    v_and_b32 v77, 0xffff0000, v77
    v_cvt_pk_bf16_f32 v79, v78, v79
    v_lshlrev_b32 v78, 16, v79
    v_and_b32 v79, 0xffff0000, v79
    v_lshlrev_b32 v80, 16, v36
    v_and_b32 v84, 0xffff0000, v36
    v_lshlrev_b32 v81, 16, v37
    v_and_b32 v85, 0xffff0000, v37
    v_lshlrev_b32 v82, 16, v38
    v_and_b32 v86, 0xffff0000, v38
    v_lshlrev_b32 v83, 16, v39
    v_and_b32 v87, 0xffff0000, v39
    v_add_f32 v72, v72, v80
    v_add_f32 v73, v73, v81
    v_add_f32 v74, v74, v82
    v_add_f32 v75, v75, v83
    v_add_f32 v76, v76, v84
    v_add_f32 v77, v77, v85
    v_add_f32 v78, v78, v86
    v_add_f32 v79, v79, v87
    v_cvt_pk_bf16_f32 v73, v72, v73
    v_lshlrev_b32 v72, 16, v73
    v_and_b32 v73, 0xffff0000, v73
    v_cvt_pk_bf16_f32 v75, v74, v75
    v_lshlrev_b32 v74, 16, v75
    v_and_b32 v75, 0xffff0000, v75
    v_cvt_pk_bf16_f32 v77, v76, v77
    v_lshlrev_b32 v76, 16, v77
    v_and_b32 v77, 0xffff0000, v77
    v_cvt_pk_bf16_f32 v79, v78, v79
    v_lshlrev_b32 v78, 16, v79
    v_and_b32 v79, 0xffff0000, v79
    v_mul_f32 v80, v72, v72
    v_mul_f32 v81, v73, v73
    v_mul_f32 v82, v74, v74
    v_mul_f32 v83, v75, v75
    v_mul_f32 v84, v76, v76
    v_mul_f32 v85, v77, v77
    v_mul_f32 v86, v78, v78
    v_mul_f32 v87, v79, v79
    v_mul_f32 v80, 0x3d372713, v80
    v_mul_f32 v81, 0x3d372713, v81
    v_mul_f32 v82, 0x3d372713, v82
    v_mul_f32 v83, 0x3d372713, v83
    v_mul_f32 v84, 0x3d372713, v84
    v_mul_f32 v85, 0x3d372713, v85
    v_mul_f32 v86, 0x3d372713, v86
    v_mul_f32 v87, 0x3d372713, v87
    v_add_f32 v80, 1.0, v80
    v_add_f32 v81, 1.0, v81
    v_add_f32 v82, 1.0, v82
    v_add_f32 v83, 1.0, v83
    v_add_f32 v84, 1.0, v84
    v_add_f32 v85, 1.0, v85
    v_add_f32 v86, 1.0, v86
    v_add_f32 v87, 1.0, v87
    v_mul_f32 v80, v80, v72
    v_mul_f32 v81, v81, v73
    v_mul_f32 v82, v82, v74
    v_mul_f32 v83, v83, v75
    v_mul_f32 v84, v84, v76
    v_mul_f32 v85, v85, v77
    v_mul_f32 v86, v86, v78
    v_mul_f32 v87, v87, v79
    v_mul_f32 v80, 0xc0135761, v80
    v_mul_f32 v81, 0xc0135761, v81
    v_mul_f32 v82, 0xc0135761, v82
    v_mul_f32 v83, 0xc0135761, v83
    v_mul_f32 v84, 0xc0135761, v84
    v_mul_f32 v85, 0xc0135761, v85
    v_mul_f32 v86, 0xc0135761, v86
    v_mul_f32 v87, 0xc0135761, v87
    v_exp_f32 v80, v80
    v_exp_f32 v81, v81
    v_exp_f32 v82, v82
    v_exp_f32 v83, v83
    v_exp_f32 v84, v84
    v_exp_f32 v85, v85
    v_exp_f32 v86, v86
    v_exp_f32 v87, v87
    v_add_f32 v80, 1.0, v80
    v_add_f32 v81, 1.0, v81
    v_add_f32 v82, 1.0, v82
    v_add_f32 v83, 1.0, v83
    v_add_f32 v84, 1.0, v84
    v_add_f32 v85, 1.0, v85
    v_add_f32 v86, 1.0, v86
    v_add_f32 v87, 1.0, v87
    v_rcp_f32 v80, v80
    v_rcp_f32 v81, v81
    v_rcp_f32 v82, v82
    v_rcp_f32 v83, v83
    v_rcp_f32 v84, v84
    v_rcp_f32 v85, v85
    v_rcp_f32 v86, v86
    v_rcp_f32 v87, v87
    v_mul_f32 v72, v72, v80
    v_mul_f32 v73, v73, v81
    v_mul_f32 v74, v74, v82
    v_mul_f32 v75, v75, v83
    v_mul_f32 v76, v76, v84
    v_mul_f32 v77, v77, v85
    v_mul_f32 v78, v78, v86
    v_mul_f32 v79, v79, v87
    v_cvt_pk_bf16_f32 v40, v72, v73
    v_cvt_pk_bf16_f32 v41, v74, v75
    v_cvt_pk_bf16_f32 v42, v76, v77
    v_cvt_pk_bf16_f32 v43, v78, v79
    s_mov_b32 vcc_lo, 0xf000f
    s_mov_b32 vcc_hi, 0xf000f
    v_cndmask_b32 v8, 0, v40, vcc
    v_cndmask_b32 v9, 0, v41, vcc
    v_cndmask_b32 v10, 0, v42, vcc
    v_cndmask_b32 v11, 0, v43, vcc
    s_mov_b32 vcc_lo, 0xf000f0
    s_mov_b32 vcc_hi, 0xf000f0
    v_cndmask_b32 v12, 0, v40, vcc
    v_cndmask_b32 v13, 0, v41, vcc
    v_cndmask_b32 v14, 0, v42, vcc
    v_cndmask_b32 v15, 0, v43, vcc
    s_mov_b32 vcc_lo, 0xf000f00
    s_mov_b32 vcc_hi, 0xf000f00
    v_cndmask_b32 v16, 0, v40, vcc
    v_cndmask_b32 v17, 0, v41, vcc
    v_cndmask_b32 v18, 0, v42, vcc
    v_cndmask_b32 v19, 0, v43, vcc
    s_mov_b32 vcc_lo, 0xf000f000
    s_mov_b32 vcc_hi, 0xf000f000
    v_cndmask_b32 v20, 0, v40, vcc
    v_cndmask_b32 v21, 0, v41, vcc
    v_cndmask_b32 v22, 0, v42, vcc
    v_cndmask_b32 v23, 0, v43, vcc
    v_mfma_f32_16x16x32_bf16 v[52:55], v[8:11], v[128:131], 0
    v_mfma_f32_16x16x32_bf16 v[56:59], v[8:11], v[132:135], 0
    v_mfma_f32_16x16x32_bf16 v[60:63], v[8:11], v[136:139], 0
    v_mfma_f32_16x16x32_bf16 v[64:67], v[8:11], v[140:143], 0
    v_mfma_f32_16x16x32_bf16 v[52:55], v[12:15], v[144:147], v[52:55]
    v_mfma_f32_16x16x32_bf16 v[56:59], v[12:15], v[148:151], v[56:59]
    v_mfma_f32_16x16x32_bf16 v[60:63], v[12:15], v[152:155], v[60:63]
    v_mfma_f32_16x16x32_bf16 v[64:67], v[12:15], v[156:159], v[64:67]
    v_mfma_f32_16x16x32_bf16 v[52:55], v[16:19], v[160:163], v[52:55]
    v_mfma_f32_16x16x32_bf16 v[56:59], v[16:19], v[164:167], v[56:59]
    v_mfma_f32_16x16x32_bf16 v[60:63], v[16:19], v[168:171], v[60:63]
    v_mfma_f32_16x16x32_bf16 v[64:67], v[16:19], v[172:175], v[64:67]
    v_mfma_f32_16x16x32_bf16 v[52:55], v[20:23], v[176:179], v[52:55]
    v_mfma_f32_16x16x32_bf16 v[56:59], v[20:23], v[180:183], v[56:59]
    v_mfma_f32_16x16x32_bf16 v[60:63], v[20:23], v[184:187], v[60:63]
    v_mfma_f32_16x16x32_bf16 v[64:67], v[20:23], v[188:191], v[64:67]
    s_nop 4
    v_permlane32_swap_b32 v52, v54
    v_permlane32_swap_b32 v53, v55
    v_permlane32_swap_b32 v56, v58
    v_permlane32_swap_b32 v57, v59
    v_permlane32_swap_b32 v60, v62
    v_permlane32_swap_b32 v61, v63
    v_permlane32_swap_b32 v64, v66
    v_permlane32_swap_b32 v65, v67
    v_add_f32 v52, v52, v54
    v_add_f32 v53, v53, v55
    v_add_f32 v56, v56, v58
    v_add_f32 v57, v57, v59
    v_add_f32 v60, v60, v62
    v_add_f32 v61, v61, v63
    v_add_f32 v64, v64, v66
    v_add_f32 v65, v65, v67
    v_permlane16_swap_b32 v52, v53
    v_permlane16_swap_b32 v56, v57
    v_permlane16_swap_b32 v60, v61
    v_permlane16_swap_b32 v64, v65
    v_add_f32 v52, v52, v53
    v_add_f32 v56, v56, v57
    v_add_f32 v60, v60, v61
    v_add_f32 v64, v64, v65
    v_add_u32 v68, 0x80, v52
    v_bfi_b32 v68, v29, s5, v68
    v_add_u32 v69, 0x80, v56
    v_bfi_b32 v69, v29, s5, v69
    v_add_u32 v70, 0x80, v60
    v_bfi_b32 v70, v29, s5, v70
    v_add_u32 v71, 0x80, v64
    v_bfi_b32 v71, v29, s5, v71
    v_mov_b32 v120, v68
    v_mov_b32 v121, v69
    v_mov_b32 v122, v70
    v_mov_b32 v123, v71
    s_mov_b32 s66, s62
    s_branch L_tr
L_H1:
    v_mov_b32 v26, -1
    v_mov_b32 v27, 0
    v_lshlrev_b32 v7, 2, v1
    ds_write_b32 v7, v26 offset:0
    s_mov_b64 exec, 0xffff
    ds_write_b32 v7, v26 offset:3072
    ds_write_b32 v7, v27 offset:256
    s_mov_b64 exec, -1
    s_waitcnt lgkmcnt(0)
    s_load_dword s6, s[32:33], 0
    s_barrier
    s_mov_b32 s40, s8
    s_mov_b32 s41, s9
    s_mov_b32 s42, 0x1000
    s_mov_b32 s43, 0x20000
    s_mov_b32 s44, s32
    s_mov_b32 s45, s33
    s_mov_b32 s46, 0x200000
    s_mov_b32 s47, 0x20000
    s_cmp_lg_u32 s3, 1
    s_cbranch_scc1 L_wo
    v_and_b32 v32, 0x1f0, v2
    s_lshl_b32 s73, s34, 9
    s_add_u32 s73, s73, 4096
    s_lshl_b32 s39, s35, 4
    s_add_u32 s39, s39, s73
    s_waitcnt lgkmcnt(0)
    s_add_u32 s4, s6, 1
    s_and_b32 s5, s4, 0xff
    s_getreg_b32 s7, hwreg(HW_REG_XCC_ID)
    s_and_b32 s7, s7, 15
    s_lshl_b32 s7, s7, 8
    s_or_b32 s7, s7, s5
    v_mov_b32 v68, s7
    v_mov_b32 v69, s7
    v_mov_b32 v70, 0
    v_mov_b32 v71, 0
    s_mov_b64 exec, 1
    buffer_store_dwordx4 v[68:71], off, s[44:47], s39
    s_mov_b64 exec, -1
    s_nop 0
    v_mov_b32 v68, s4
    v_mov_b32 v69, 1
    ds_write_b64 v27, v[68:69] offset:264
    s_mul_i32 s60, s36, 8192
    s_lshl_b32 s39, s37, 8
    s_add_u32 s60, s60, s39
    s_add_u32 s60, s60, 1572864
    s_add_u32 s61, s60, 1024
    s_mov_b32 s39, 2048
    v_lshlrev_b32 v5, 4, v3
    v_mad_u32_u24 v7, v4, s39, v5
    v_bfe_u32 v5, v1, 2, 2
    v_and_b32 v6, 3, v1
    v_lshl_add_u32 v6, v5, 4, v6
    v_lshl_add_u32 v6, v4, 2, v6
    v_lshlrev_b32 v6, 1, v6
    v_mov_b32 v26, 0
    s_mov_b32 s72, 131072
    s_nop 0
L_qw:
    ds_read_b32 v27, v26 offset:272
    s_waitcnt lgkmcnt(0)
    v_cmp_gt_u32 vcc, 28, v27
    s_nop 0
    s_cbranch_vccz L_qwd
    s_sleep 4
    s_sub_u32 s72, s72, 1
    s_cbranch_scc0 L_qw
L_qwd:
    s_mov_b32 s72, 131072
    buffer_load_dwordx4 v[72:75], v7, s[44:47], s60 offen nt
    buffer_load_dwordx4 v[76:79], v7, s[44:47], s61 offen nt
L_pl4:
    s_waitcnt vmcnt(0)
    v_xor_b32 v26, s5, v72
    v_xor_b32 v27, s5, v73
    v_bitop3_b32 v26, v74, v26, s5 bitop3:0xde
    v_bitop3_b32 v27, v75, v27, s5 bitop3:0xde
    v_bitop3_b32 v26, v76, v26, s5 bitop3:0xde
    v_bitop3_b32 v27, v77, v27, s5 bitop3:0xde
    v_bitop3_b32 v26, v78, v26, s5 bitop3:0xde
    v_bitop3_b32 v27, v79, v27, s5 bitop3:0xde
    v_or_b32 v26, v26, v27
    v_and_b32 v26, 0xff, v26
    s_nop 1
    v_or_b32_dpp v26, v26, v26 quad_perm:[1,0,3,2] row_mask:0xf bank_mask:0xf
    s_nop 1
    v_or_b32_dpp v26, v26, v26 quad_perm:[2,3,0,1] row_mask:0xf bank_mask:0xf
    s_nop 1
    v_or_b32_dpp v26, v26, v26 row_half_mirror row_mask:0xf bank_mask:0xf
    v_cmp_ne_u32 vcc, 0, v26
    s_nop 0
    s_cbranch_vccz L_pl4d
    s_sleep 8
    s_mov_b64 exec, vcc
    buffer_load_dwordx4 v[72:75], v7, s[44:47], s60 offen sc1
    buffer_load_dwordx4 v[76:79], v7, s[44:47], s61 offen sc1
    s_mov_b64 exec, -1
    s_sub_u32 s72, s72, 1
    s_cbranch_scc0 L_pl4
    s_waitcnt vmcnt(0)
L_pl4d:
    v_and_b32 v72, 0xffffff00, v72
    v_and_b32 v73, 0xffffff00, v73
    v_and_b32 v74, 0xffffff00, v74
    v_and_b32 v75, 0xffffff00, v75
    v_and_b32 v76, 0xffffff00, v76
    v_and_b32 v77, 0xffffff00, v77
    v_and_b32 v78, 0xffffff00, v78
    v_and_b32 v79, 0xffffff00, v79
    v_permlane32_swap_b32 v72, v74
    v_permlane32_swap_b32 v73, v75
    v_permlane32_swap_b32 v76, v78
    v_permlane32_swap_b32 v77, v79
    v_add_f32 v72, v72, v74
    v_add_f32 v73, v73, v75
    v_add_f32 v76, v76, v78
    v_add_f32 v77, v77, v79
    v_permlane16_swap_b32 v72, v73
    s_nop 0
    v_permlane16_swap_b32 v76, v77
    v_add_f32 v72, v72, v73
    v_add_f32 v76, v76, v77
    v_cvt_pk_bf16_f32 v72, v72, v76
    v_mov_b32 v73, 0xfffefffe
    v_pk_min_u16 v72, v72, v73
    ds_write_b16 v6, v72 offset:0
    ds_write_b16_d16_hi v6, v72 offset:128
    buffer_load_dwordx2 v[36:37], v32, s[44:47], s73 offen nt
    s_mov_b32 s72, 8
    s_mov_b32 s74, 1
L_c1:
    s_waitcnt vmcnt(0)
    v_xor_b32 v36, s7, v36
    v_bitop3_b32 v36, v37, v36, s7 bitop3:0xde
    v_cmp_ne_u32 vcc, 0, v36
    s_nop 0
    s_cbranch_vccz L_c1d
    v_and_b32 v37, 0xfffff0ff, v36
    v_cmp_eq_u32 s[70:71], 0, v37
    s_and_b64 vcc, vcc, s[70:71]
    s_nop 2
    s_cbranch_scc1 L_c1f
    s_sleep 8
    buffer_load_dwordx2 v[36:37], v32, s[44:47], s73 offen nt
    s_sub_u32 s72, s72, 1
    s_cbranch_scc0 L_c1
    s_waitcnt vmcnt(0)
L_c1f:
    s_mov_b32 s74, 0
L_c1d:
    s_lshl_b32 s63, s37, 5
    s_add_u32 s63, s63, s36
    s_mul_i32 s63, s63, 256
    s_add_u32 s63, s63, 786432
    s_lshl_b32 s39, s38, 7
    s_add_u32 s66, s63, s39
    v_and_b32 v6, 16, v2
    s_mov_b64 exec, 0xff
    s_mov_b32 s72, 131072
L_mw:
    ds_read_b128 v[8:11], v6 offset:3072
    s_waitcnt lgkmcnt(0)
    v_max_u32 v26, v9, v11
    v_cmp_eq_u32 vcc, -1, v26
    s_nop 0
    s_cbranch_vccz L_mwd
    s_sleep 16
    s_sub_u32 s72, s72, 1
    s_cbranch_scc0 L_mw
L_mwd:
    v_bfi_b32 v68, v29, s5, v8
    v_bfi_b32 v69, v29, s5, v9
    v_bfi_b32 v70, v29, s5, v10
    v_bfi_b32 v71, v29, s5, v11
    s_cmp_eq_u32 s74, 0
    s_cbranch_scc1 L_st5
    buffer_store_dwordx4 v[68:71], v2, s[44:47], s66 offen
    s_nop 0
    s_branch L_st5d
L_st5:
    buffer_store_dwordx4 v[68:71], v2, s[44:47], s66 offen sc1
    s_nop 1
L_st5d:
    s_mov_b64 exec, 0xff
    v_and_b32 v6, 3, v1
    v_lshlrev_b32 v6, 3, v6
    v_lshrrev_b32 v26, 2, v1
    v_lshl_add_u32 v6, v26, 7, v6
    v_mov_b32 v26, 0
    s_mov_b32 s72, 131072
    s_nop 0
L_mg:
    ds_read_b32 v27, v26 offset:272
    s_waitcnt lgkmcnt(0)
    v_cmp_gt_u32 vcc, 166, v27
    s_nop 0
    s_cbranch_vccz L_mgd
    s_sleep 16
    s_sub_u32 s72, s72, 1
    s_cbranch_scc0 L_mg
L_mgd:
    s_mov_b32 s72, 131072
    buffer_load_dwordx2 v[8:9], v6, s[44:47], s63 offen nt
L_pl6:
    s_waitcnt vmcnt(0)
    v_xor_b32 v26, s5, v8
    v_xor_b32 v27, s5, v9
    v_or_b32 v26, v26, v27
    v_and_b32 v26, 0xff, v26
    s_nop 1
    v_or_b32_dpp v26, v26, v26 quad_perm:[1,0,3,2] row_mask:0xf bank_mask:0xf
    s_nop 1
    v_or_b32_dpp v26, v26, v26 quad_perm:[2,3,0,1] row_mask:0xf bank_mask:0xf
    s_nop 1
    v_or_b32_dpp v26, v26, v26 row_half_mirror row_mask:0xf bank_mask:0xf
    v_cmp_ne_u32 vcc, 0, v26
    s_nop 0
    s_cbranch_vccz L_pl6d
    s_sleep 32
    s_mov_b64 exec, vcc
    buffer_load_dwordx2 v[8:9], v6, s[44:47], s63 offen sc1
    s_mov_b64 exec, 0xff
    s_sub_u32 s72, s72, 1
    s_cbranch_scc0 L_pl6
    s_waitcnt vmcnt(0)
L_pl6d:
    v_and_b32 v8, 0xffffff00, v8
    v_and_b32 v9, 0xffffff00, v9
    s_nop 0
    v_max_f32_dpp v26, v8, v8 quad_perm:[1,0,3,2] row_mask:0xf bank_mask:0xf
    s_nop 1
    v_max_f32_dpp v26, v26, v26 quad_perm:[2,3,0,1] row_mask:0xf bank_mask:0xf
    s_nop 1
    v_max_f32_dpp v26, v26, v26 row_half_mirror row_mask:0xf bank_mask:0xf
    v_sub_f32 v8, v8, v26
    v_mul_f32 v8, 0x3fb8aa3b, v8
    v_exp_f32 v8, v8
    s_nop 0
    v_mul_f32 v26, v8, v9
    s_nop 1
    v_add_f32_dpp v26, v26, v26 quad_perm:[1,0,3,2] row_mask:0xf bank_mask:0xf
    s_nop 1
    v_add_f32_dpp v26, v26, v26 quad_perm:[2,3,0,1] row_mask:0xf bank_mask:0xf
    s_nop 1
    v_add_f32_dpp v26, v26, v26 row_half_mirror row_mask:0xf bank_mask:0xf
    v_rcp_f32 v26, v26
    s_nop 0
    v_mul_f32 v8, v8, v26
    v_and_b32 v6, 3, v1
    v_lshlrev_b32 v6, 2, v6
    s_lshl_b32 s39, s38, 2
    s_lshl_b32 s64, 0xf, s39
    s_mov_b32 s65, 0
    s_mov_b64 exec, s[64:65]
    ds_write_b32 v6, v8 offset:3136
    s_mov_b64 exec, -1
L_ml2:
    s_and_b32 s39, s35, 6
    s_cmp_lg_u32 s39, 0
    s_cbranch_scc1 L_tr
    s_mov_b32 s68, s26
    s_mov_b32 s69, s27
    s_mov_b32 s70, 0x400
    s_mov_b32 s71, 0x20000
    s_lshl_b32 s58, s34, 1
    s_add_u32 s58, s58, s38
    s_lshl_b32 s58, s58, 6
    s_lshl_b32 s39, s37, 10
    s_add_u32 s59, s58, s39
    v_and_b32 v5, 4, v1
    v_add_u32 v5, v5, v4
    v_and_b32 v6, 3, v1
    v_lshl_add_u32 v5, v5, 2, v6
    v_lshlrev_b32 v5, 1, v5
    buffer_load_ushort v16, v5, s[68:71], s58 offen
    buffer_load_ushort v17, v5, s[40:43], s59 offen
    s_mul_i32 s64, s34, 1024
    s_and_b32 s39, s64, 0x1000
    s_add_u32 s64, s64, s39
    s_lshl_b32 s39, s37, 8
    s_add_u32 s64, s64, s39
    s_lshl_b32 s39, s38, 7
    s_add_u32 s64, s64, s39
    s_add_u32 s64, s64, 524288
    s_add_u32 s65, s64, 49152
    v_lshrrev_b32 v20, 3, v1
    v_and_b32 v5, 0x70, v2
    s_mov_b32 s39, 8192
    v_mad_u32_u24 v20, v20, s39, v5
    v_and_b32 v5, 8, v1
    v_lshlrev_b32 v5, 9, v5
    v_sub_u32 v20, v20, v5
    v_lshlrev_b32 v21, 2, v1
    v_mov_b32 v18, -1
    s_mov_b32 s67, 1
    s_waitcnt vmcnt(0)
    v_lshlrev_b32 v16, 16, v16
    v_lshlrev_b32 v17, 16, v17
    ds_write_b32 v21, v18 offset:3200
    ds_write_b32 v21, v17 offset:3456
    s_branch L_tr
L_wo:
    s_mov_b32 s68, s22
    s_mov_b32 s69, s23
    s_mov_b32 s70, 0xe00
    s_mov_b32 s71, 0x20000
    s_lshl_b32 s39, s34, 9
    v_lshlrev_b32 v13, 7, v1
    s_mov_b64 exec, 15
    buffer_load_dword v14, v13, s[68:71], s39 offen
    s_mov_b32 s68, s26
    s_mov_b32 s69, s27
    s_mov_b32 s70, 0x400
    s_mov_b32 s71, 0x20000
    s_lshl_b32 s39, s34, 7
    s_mov_b64 exec, 1
    buffer_load_dword v15, v13, s[68:71], s39 offen
    s_mov_b64 exec, -1
    s_mov_b32 s48, s16
    s_mov_b32 s49, s17
    s_mov_b32 s50, 0x400000
    s_mov_b32 s51, 0x20000
    s_and_b32 s56, s3, 1
    s_lshl_b32 s60, s36, 17
    s_lshl_b32 s39, s56, 10
    s_add_u32 s60, s60, s39
    s_mul_i32 s39, s56, 1040
    s_add_u32 m0, s39, 20480
    s_mov_b32 s64, 64
    s_lshl_b32 s39, s34, 2
    s_lshr_b32 s63, 0x20002244, s39
    s_and_b32 s63, s63, 15
    s_add_u32 s61, s63, 7
    v_mov_b32 v26, 0
    s_mov_b32 s72, 131072
    s_nop 0
L_pm:
    ds_read_b32 v27, v26 offset:272
    s_waitcnt lgkmcnt(0)
    v_cmp_gt_u32 vcc, s61, v27
    s_nop 0
    s_cbranch_vccz L_pmd
    s_sleep 2
    s_sub_u32 s72, s72, 1
    s_cbranch_scc0 L_pm
L_pmd:
    s_cmp_eq_u32 s34, 7
    s_cbranch_scc1 L_pm9
    s_and_b32 s39, s35, 15
    s_lshl_b32 s39, s39, 1
    s_add_u32 s39, s39, s56
    s_cmp_ge_u32 s37, 2
    s_cbranch_scc1 L_pm2
    s_mul_i32 s62, s39, 57344
    s_lshl_b32 s39, s34, 9
    s_add_u32 s62, s62, s39
    v_lshrrev_b32 v8, 2, v1
    v_mul_u32_u24 v8, 28, v8
    v_and_b32 v11, 3, v1
    v_add_lshl_u32 v8, v8, v11, 7
    s_mov_b32 s52, s20
    s_mov_b32 s53, s21
    s_mov_b32 s54, 0x1c0000
    s_mov_b32 s55, 0x20000
    s_branch L_pm3
L_pm2:
    s_lshl_b32 s62, s34, 18
    s_lshl_b32 s39, s39, 13
    s_add_u32 s62, s62, s39
    v_lshlrev_b32 v8, 7, v1
    s_mov_b32 s52, s24
    s_mov_b32 s53, s25
    s_mov_b32 s54, 0x1c0000
    s_mov_b32 s55, 0x20000
L_pm3:
    buffer_load_dword v9, v8, s[52:55], s62 offen nt
    buffer_load_dword v10, v8, s[52:55], s62 offen sc1
L_pm9:
    s_add_u32 s61, s63, 9
    v_mov_b32 v26, 0
    s_mov_b32 s72, 131072
    s_nop 0
L_pw:
    ds_read_b32 v27, v26 offset:272
    s_waitcnt lgkmcnt(0)
    v_cmp_gt_u32 vcc, s61, v27
    s_nop 0
    s_cbranch_vccz L_pwd
    s_sleep 2
    s_sub_u32 s72, s72, 1
    s_cbranch_scc0 L_pw
L_pwd:
    v_and_b32 v12, 7, v1
    v_lshlrev_b32 v12, 7, v12
    v_bfe_u32 v11, v1, 3, 1
    v_lshl_add_u32 v12, v11, 10, v12
    v_bfe_u32 v11, v1, 4, 1
    v_lshl_add_u32 v12, v11, 11, v12
    v_bfe_u32 v11, v1, 5, 1
    v_lshl_add_u32 v12, v11, 12, v12
    s_lshl_b32 s62, s36, 17
    s_lshl_b32 s39, s56, 13
    s_add_u32 s62, s62, s39
    s_lshl_b32 s39, s38, 14
    s_add_u32 s62, s62, s39
    s_bfe_u32 s39, s37, 0x10000
    s_lshl_b32 s39, s39, 15
    s_add_u32 s62, s62, s39
    s_bfe_u32 s39, s37, 0x10001
    s_lshl_b32 s39, s39, 16
    s_add_u32 s62, s62, s39
    buffer_load_dword v9, v12, s[48:51], s62 offen nt
    buffer_load_dword v10, v12, s[48:51], s62 offen sc1
    s_lshl_b32 s39, s2, 2
    s_add_u32 s39, s39, s3
    s_cmp_lg_u32 s39, 3
    s_cbranch_scc1 L_nr
    s_load_dword s61, s[32:33], 0x8080
    s_waitcnt lgkmcnt(0)
    s_memtime s[52:53]
    s_mov_b32 s57, 0
    s_load_dword s61, s[32:33], 0x8000
    s_waitcnt lgkmcnt(0)
    s_memtime s[54:55]
    s_waitcnt lgkmcnt(0)
    s_sub_u32 s39, s54, s52
    s_min_u32 s39, s39, 2400
    s_sub_u32 s57, s57, s39
    s_load_dword s61, s[32:33], 0xa000
    s_waitcnt lgkmcnt(0)
    s_memtime s[52:53]
    s_waitcnt lgkmcnt(0)
    s_sub_u32 s39, s52, s54
    s_min_u32 s39, s39, 2400
    s_add_u32 s57, s57, s39
    s_load_dword s61, s[32:33], 0xb500
    s_waitcnt lgkmcnt(0)
    s_memtime s[54:55]
    s_waitcnt lgkmcnt(0)
    s_sub_u32 s39, s54, s52
    s_min_u32 s39, s39, 2400
    s_add_u32 s57, s57, s39
    s_load_dword s61, s[32:33], 0x9500
    s_waitcnt lgkmcnt(0)
    s_memtime s[52:53]
    s_waitcnt lgkmcnt(0)
    s_sub_u32 s39, s52, s54
    s_min_u32 s39, s39, 2400
    s_sub_u32 s57, s57, s39
    s_load_dword s61, s[32:33], 0xca00
    s_waitcnt lgkmcnt(0)
    s_memtime s[54:55]
    s_waitcnt lgkmcnt(0)
    s_sub_u32 s39, s54, s52
    s_min_u32 s39, s39, 2400
    s_sub_u32 s57, s57, s39
    s_load_dword s61, s[32:33], 0xea00
    s_waitcnt lgkmcnt(0)
    s_memtime s[52:53]
    s_waitcnt lgkmcnt(0)
    s_sub_u32 s39, s52, s54
    s_min_u32 s39, s39, 2400
    s_add_u32 s57, s57, s39
    s_load_dword s61, s[32:33], 0xff00
    s_waitcnt lgkmcnt(0)
    s_memtime s[54:55]
    s_waitcnt lgkmcnt(0)
    s_sub_u32 s39, s54, s52
    s_min_u32 s39, s39, 2400
    s_add_u32 s57, s57, s39
    s_load_dword s61, s[32:33], 0xdf00
    s_waitcnt lgkmcnt(0)
    s_memtime s[52:53]
    s_waitcnt lgkmcnt(0)
    s_sub_u32 s39, s52, s54
    s_min_u32 s39, s39, 2400
    s_sub_u32 s57, s57, s39
    s_lshr_b32 s57, s57, 31
    s_lshl_b32 s57, s57, 13
    s_add_u32 s4, s6, 1
    s_xnor_b32 s57, s57, s4
    v_mov_b32 v26, s4
    v_mov_b32 v27, s57
    s_mov_b32 s39, 12288
    s_mov_b64 exec, 1
    buffer_store_dwordx2 v[26:27], off, s[44:47], s39 sc1
    s_mov_b64 exec, -1
L_nr:
    v_mov_b32 v26, 0
    s_mov_b32 s72, 131072
    s_nop 0
L_ws:
    ds_read_b32 v27, v26 offset:272
    s_waitcnt lgkmcnt(0)
    v_cmp_gt_u32 vcc, 40, v27
    s_nop 0
    s_cbranch_vccz L_wsd
    s_sleep 4
    s_sub_u32 s72, s72, 1
    s_cbranch_scc0 L_ws
L_wsd:
L_wo1:
    s_waitcnt vmcnt(2)
    buffer_load_dwordx4 v2, s[48:51], s60 offen nt lds
    s_add_u32 s60, s60, 0x800
    s_add_u32 m0, m0, 2080
    s_sub_u32 s64, s64, 1
    s_cmp_lg_u32 s64, 0
    s_cbranch_scc1 L_wo1
L_wo2:
    s_mov_b32 s72, 131072
L_wq:
    ds_read_b32 v27, v7 offset:0
    s_waitcnt lgkmcnt(0)
    v_cmp_eq_u32 vcc, -1, v27
    s_nop 0
    s_cbranch_vccz L_wqd
    s_sleep 4
    s_sub_u32 s72, s72, 1
    s_cbranch_scc0 L_wq
L_wqd:
    v_mov_b32 v26, 0
    ds_read_b32 v26, v26 offset:264
    s_waitcnt lgkmcnt(0)
    v_readfirstlane_b32 s4, v26
    v_mov_b32 v28, v29
    s_cmp_eq_u32 s56, 0
    s_nop 1
    s_cbranch_scc1 L_xd
    s_mov_b32 s72, 131072
    s_mov_b32 s39, 12288
L_xp:
    buffer_load_dwordx2 v[26:27], off, s[44:47], s39 sc1
    s_waitcnt vmcnt(0)
L_xc:
    v_xnor_b32 v27, s4, v27
    v_xor_b32 v26, s4, v26
    v_or_b32 v28, v29, v27
    v_and_b32 v27, 0xffffdfff, v27
    v_or_b32 v26, v26, v27
    v_cmp_ne_u32 vcc, 0, v26
    s_nop 0
    s_cbranch_vccz L_xd
    s_sleep 8
    s_sub_u32 s72, s72, 1
    s_cbranch_scc0 L_xp
L_xd:
    s_lshl_b32 s39, s56, 2
    s_and_b32 s5, s4, 0xff
    v_mov_b32 v26, s39
    s_waitcnt vmcnt(0)
    ds_write_b32 v26, v28 offset:256
L_tr:
    s_mov_b32 s76, s30
    s_mov_b32 s77, s31
    s_mov_b32 s78, 0x100
    s_mov_b32 s79, 0x20000
    s_mul_i32 s96, s35, 8
    s_lshr_b32 s96, s96, 5
    s_add_u32 s96, s96, 64
    s_add_u32 s97, s35, 1
    s_lshl_b32 s98, s34, 9
    s_add_u32 s98, s98, 4096
    s_lshl_b32 s101, s35, 4
    s_add_u32 s101, s101, s98
    s_mul_i32 s60, s34, 4
    s_xor_b32 s60, s60, s35
    s_and_b32 s60, s60, 31
    s_mul_i32 s61, s34, 32
    s_add_u32 s61, s61, 0
    s_mov_b32 s62, 0
    s_mov_b32 s39, 32
    v_mul_u32_u24 v35, s39, v1
    v_mov_b32 v34, 0
    v_mov_b32 v41, 0
    s_mov_b32 s52, 0xfd03fd03
    s_mov_b32 s53, 0xf605fd05
    s_lshl_b32 s39, s34, 3
    s_lshr_b64 s[52:53], s[52:53], s39
    s_sext_i32_i8 s58, s52
    s_cmp_lg_u32 s3, 0
    s_cbranch_scc1 L_tr2
    v_mov_b32 v26, 0
    v_and_b32 v28, 3, v1
    v_lshlrev_b32 v28, 2, v28
    s_cmp_eq_u32 s74, 0
    s_cbranch_scc1 L_cax
    s_mov_b32 exec_hi, 0
L_ca:
    s_cmp_gt_u32 s96, 160
    s_cbranch_scc1 L_cax
    v_add_u32 v34, 1, v34
    s_sub_u32 s39, s96, 56
    s_lshr_b32 s39, s39, 3
    v_mov_b32 v40, s39
    s_mov_b32 s72, 131072
    s_nop 0
L_caw:
    ds_read_b32 v27, v26 offset:272
    s_waitcnt lgkmcnt(0)
    v_cmp_gt_u32 vcc, s96, v27
    s_nop 0
    s_cbranch_vccz L_cawd
    s_sleep 1
    s_sub_u32 s72, s72, 1
    s_cbranch_scc0 L_caw
L_cawd:
    v_readfirstlane_b32 s99, v27
    s_sub_u32 s99, s99, s96
    s_max_i32 s99, s99, 0
    s_lshr_b32 s39, s99, 3
    s_andn2_b32 s99, s99, 7
    v_add_u32 v34, s39, v34
    s_add_u32 s96, s96, s99
    s_lshl_b32 s39, s39, 5
    s_add_u32 s97, s97, s39
    s_mov_b32 exec_lo, 1
    buffer_store_dword v34, off, s[44:47], s101 offset:12
    s_mov_b32 exec_lo, -1
    buffer_load_dwordx2 v[36:37], v2, s[44:47], s98 offen offset:8 nt
    s_waitcnt vmcnt(0)
L_cam:
    v_readfirstlane_b32 s99, v27
    ds_read_b32 v27, v26 offset:272
    s_sub_u32 s99, s99, s96
    s_add_u32 s96, s96, 8
    s_mul_i32 s99, s99, 4
    s_add_u32 s99, s99, s97
    s_add_u32 s97, s97, 32
    v_add_u32_dpp v36, v36, v36 quad_perm:[1,0,3,2] row_mask:0xf bank_mask:0xf
    v_add_u32_dpp v37, v37, v37 quad_perm:[1,0,3,2] row_mask:0xf bank_mask:0xf
    s_nop 0
    v_add_u32_dpp v36, v36, v36 quad_perm:[2,3,0,1] row_mask:0xf bank_mask:0xf
    v_add_u32_dpp v37, v37, v37 quad_perm:[2,3,0,1] row_mask:0xf bank_mask:0xf
    s_nop 0
    v_add_u32_dpp v36, v36, v36 row_half_mirror row_mask:0xf bank_mask:0xf
    v_add_u32_dpp v37, v37, v37 row_half_mirror row_mask:0xf bank_mask:0xf
    s_nop 0
    v_add_u32_dpp v36, v36, v36 row_mirror row_mask:0xf bank_mask:0xf
    v_add_u32_dpp v37, v37, v37 row_mirror row_mask:0xf bank_mask:0xf
    v_readlane_b32 s100, v36, 0
    v_readlane_b32 s39, v36, 16
    s_add_u32 s100, s100, s39
    v_readlane_b32 s63, v37, 0
    v_readlane_b32 s39, v37, 16
    s_add_u32 s63, s63, s39
    s_sub_i32 s99, s63, s99
    s_mul_i32 s99, s99, 3
    s_add_i32 s100, s100, s99
    s_add_i32 s100, s100, s58
    s_ashr_i32 s100, s100, 3
    s_add_i32 s100, s100, 4
    s_max_i32 s100, s100, 0
    s_waitcnt lgkmcnt(0)
    v_add_u32 v27, s100, v27
    ds_write_b32 v28, v27 offset:288
    s_branch L_ca
L_cax:
    s_mov_b64 exec, -1
L_tr2:
    v_and_b32 v26, 1, v1
    v_lshlrev_b32 v26, 2, v26
    s_mov_b32 s72, 131072
    s_nop 0
L_wf:
    ds_read_b32 v27, v26 offset:256
    s_waitcnt lgkmcnt(0)
    v_cmp_eq_u32 vcc, 0, v27
    s_nop 0
    s_cbranch_vccz L_wfd
    s_sleep 8
    s_sub_u32 s72, s72, 1
    s_cbranch_scc0 L_wf
L_wfd:
    v_readlane_b32 s62, v27, 1
    s_and_b32 s62, s62, 0x2000
    s_xor_b32 s64, s64, s62
    s_xor_b32 s65, s65, s62
    s_cmp_eq_u32 s66, -1
    s_cselect_b32 s39, 0, s62
    s_xor_b32 s66, s66, s39
    v_bfe_u32 v26, v1, 2, 2
    v_lshl_add_u32 v26, v4, 3, v26
    v_and_b32 v7, 3, v1
    v_lshlrev_b32 v7, 5, v7
    s_mov_b32 s39, 1040
    v_mad_u32_u24 v7, v26, s39, v7
    s_lshl_b32 s39, s3, 8
    s_add_u32 s39, s39, 20480
    v_add_u32 v7, s39, v7
    v_add_u32 v6, 66560, v7
    ds_read_b64_tr_b16 v[128:129], v7 offset:0
    ds_read_b64_tr_b16 v[130:131], v7 offset:4160
    ds_read_b64_tr_b16 v[132:133], v7 offset:33280
    ds_read_b64_tr_b16 v[134:135], v7 offset:37440
    ds_read_b64_tr_b16 v[136:137], v6 offset:0
    ds_read_b64_tr_b16 v[138:139], v6 offset:4160
    ds_read_b64_tr_b16 v[140:141], v6 offset:33280
    ds_read_b64_tr_b16 v[142:143], v6 offset:37440
    ds_read_b64_tr_b16 v[144:145], v7 offset:8
    ds_read_b64_tr_b16 v[146:147], v7 offset:4168
    ds_read_b64_tr_b16 v[148:149], v7 offset:33288
    ds_read_b64_tr_b16 v[150:151], v7 offset:37448
    ds_read_b64_tr_b16 v[152:153], v6 offset:8
    ds_read_b64_tr_b16 v[154:155], v6 offset:4168
    ds_read_b64_tr_b16 v[156:157], v6 offset:33288
    ds_read_b64_tr_b16 v[158:159], v6 offset:37448
    ds_read_b64_tr_b16 v[160:161], v7 offset:16
    ds_read_b64_tr_b16 v[162:163], v7 offset:4176
    ds_read_b64_tr_b16 v[164:165], v7 offset:33296
    ds_read_b64_tr_b16 v[166:167], v7 offset:37456
    ds_read_b64_tr_b16 v[168:169], v6 offset:16
    ds_read_b64_tr_b16 v[170:171], v6 offset:4176
    ds_read_b64_tr_b16 v[172:173], v6 offset:33296
    ds_read_b64_tr_b16 v[174:175], v6 offset:37456
    ds_read_b64_tr_b16 v[176:177], v7 offset:24
    ds_read_b64_tr_b16 v[178:179], v7 offset:4184
    ds_read_b64_tr_b16 v[180:181], v7 offset:33304
    ds_read_b64_tr_b16 v[182:183], v7 offset:37464
    ds_read_b64_tr_b16 v[184:185], v6 offset:24
    ds_read_b64_tr_b16 v[186:187], v6 offset:4184
    ds_read_b64_tr_b16 v[188:189], v6 offset:33304
    ds_read_b64_tr_b16 v[190:191], v6 offset:37464
    ds_read_b64_tr_b16 v[192:193], v7 offset:128
    ds_read_b64_tr_b16 v[194:195], v7 offset:4288
    ds_read_b64_tr_b16 v[196:197], v7 offset:33408
    ds_read_b64_tr_b16 v[198:199], v7 offset:37568
    ds_read_b64_tr_b16 v[200:201], v6 offset:128
    ds_read_b64_tr_b16 v[202:203], v6 offset:4288
    ds_read_b64_tr_b16 v[204:205], v6 offset:33408
    ds_read_b64_tr_b16 v[206:207], v6 offset:37568
    ds_read_b64_tr_b16 v[208:209], v7 offset:136
    ds_read_b64_tr_b16 v[210:211], v7 offset:4296
    ds_read_b64_tr_b16 v[212:213], v7 offset:33416
    ds_read_b64_tr_b16 v[214:215], v7 offset:37576
    ds_read_b64_tr_b16 v[216:217], v6 offset:136
    ds_read_b64_tr_b16 v[218:219], v6 offset:4296
    ds_read_b64_tr_b16 v[220:221], v6 offset:33416
    ds_read_b64_tr_b16 v[222:223], v6 offset:37576
    ds_read_b64_tr_b16 v[224:225], v7 offset:144
    ds_read_b64_tr_b16 v[226:227], v7 offset:4304
    ds_read_b64_tr_b16 v[228:229], v7 offset:33424
    ds_read_b64_tr_b16 v[230:231], v7 offset:37584
    ds_read_b64_tr_b16 v[232:233], v6 offset:144
    ds_read_b64_tr_b16 v[234:235], v6 offset:4304
    ds_read_b64_tr_b16 v[236:237], v6 offset:33424
    ds_read_b64_tr_b16 v[238:239], v6 offset:37584
    ds_read_b64_tr_b16 v[240:241], v7 offset:152
    ds_read_b64_tr_b16 v[242:243], v7 offset:4312
    ds_read_b64_tr_b16 v[244:245], v7 offset:33432
    ds_read_b64_tr_b16 v[246:247], v7 offset:37592
    ds_read_b64_tr_b16 v[248:249], v6 offset:152
    ds_read_b64_tr_b16 v[250:251], v6 offset:4312
    ds_read_b64_tr_b16 v[252:253], v6 offset:33432
    ds_read_b64_tr_b16 v[254:255], v6 offset:37592
    v_and_b32 v6, 3, v1
    v_lshlrev_b32 v6, 8, v6
    v_lshl_add_u32 v6, v4, 4, v6
    v_mov_b32 v5, 0
    v_lshlrev_b32 v7, 2, v1
    s_waitcnt lgkmcnt(0)
    s_lshl_b32 s59, s37, 5
    s_add_u32 s59, s59, s36
    s_lshl_b32 s59, s59, 1
    s_add_u32 s59, s59, s38
    s_and_b32 s39, s59, 7
    s_lshr_b32 s59, s59, 3
    s_lshl_b32 s59, s59, 14
    s_lshl_b32 s39, s39, 10
    s_add_u32 s59, s59, s39
    s_and_b32 s39, s3, 1
    s_lshl_b32 s39, s39, 9
    s_add_u32 s59, s59, s39
    s_lshr_b32 s39, s3, 1
    s_lshl_b32 s39, s39, 13
    s_add_u32 s59, s59, s39
    s_add_u32 s59, s59, 1048576
    s_xor_b32 s59, s59, s62
    v_lshl_add_u32 v6, v4, 4, v6
    v_and_b32 v7, 4, v1
    v_lshl_add_u32 v6, v7, 2, v6
    v_cmp_eq_u32 vcc, 0, v7
    v_mov_b32 v7, 0xeeee
    v_mov_b32 v44, 0x4444
    v_cndmask_b32 v7, v7, v44, vcc
    s_mov_b32 s56, 0x00ff00ff
    s_mov_b32 s57, 0x00ff00ff
    v_mov_b32 v72, 0
    v_mov_b32 v92, 0
    v_mov_b32 v73, 0
    v_mov_b32 v93, 0
    v_mov_b32 v74, 0
    v_mov_b32 v94, 0
    v_mov_b32 v75, 0
    v_mov_b32 v95, 0
    v_mov_b32 v76, 0
    v_mov_b32 v96, 0
    v_mov_b32 v77, 0
    v_mov_b32 v97, 0
    v_mov_b32 v78, 0
    v_mov_b32 v98, 0
    v_mov_b32 v79, 0
    v_mov_b32 v99, 0
    v_mov_b32 v80, 0
    v_mov_b32 v100, 0
    v_mov_b32 v81, 0
    v_mov_b32 v101, 0
    v_mov_b32 v82, 0
    v_mov_b32 v102, 0
    v_mov_b32 v83, 0
    v_mov_b32 v103, 0
    v_mov_b32 v84, 0
    v_mov_b32 v104, 0
    v_mov_b32 v85, 0
    v_mov_b32 v105, 0
    v_mov_b32 v86, 0
    v_mov_b32 v106, 0
    v_mov_b32 v87, 0
    v_mov_b32 v107, 0
    s_cmp_lg_u32 s3, 0
    s_cbranch_scc1 L_tr3
    v_mov_b32 v26, 0
    v_and_b32 v28, 3, v1
    v_lshlrev_b32 v28, 2, v28
    s_cmp_eq_u32 s74, 0
    s_cbranch_scc1 L_cbx
    s_mov_b32 exec_hi, 0
L_cb:
    s_cmp_gt_u32 s96, 250
    s_cbranch_scc1 L_cbx
    v_add_u32 v34, 1, v34
    s_sub_u32 s39, s96, 56
    s_lshr_b32 s39, s39, 3
    v_mov_b32 v40, s39
    s_mov_b32 s72, 131072
    s_nop 0
L_cbw:
    ds_read_b32 v27, v26 offset:272
    s_waitcnt lgkmcnt(0)
    v_cmp_gt_u32 vcc, s96, v27
    s_nop 0
    s_cbranch_vccz L_cbwd
    s_sleep 1
    s_sub_u32 s72, s72, 1
    s_cbranch_scc0 L_cbw
L_cbwd:
    v_readfirstlane_b32 s99, v27
    s_sub_u32 s99, s99, s96
    s_max_i32 s99, s99, 0
    s_lshr_b32 s39, s99, 3
    s_andn2_b32 s99, s99, 7
    v_add_u32 v34, s39, v34
    s_add_u32 s96, s96, s99
    s_lshl_b32 s39, s39, 5
    s_add_u32 s97, s97, s39
    s_mov_b32 exec_lo, 1
    buffer_store_dword v34, off, s[44:47], s101 offset:12
    s_cmp_gt_u32 s96, 236
    s_cbranch_scc1 L_cbx
    s_mov_b32 exec_lo, -1
    buffer_load_dwordx2 v[36:37], v2, s[44:47], s98 offen offset:8 nt
    s_waitcnt vmcnt(0)
L_cbm:
    v_readfirstlane_b32 s99, v27
    ds_read_b32 v27, v26 offset:272
    s_sub_u32 s99, s99, s96
    s_add_u32 s96, s96, 8
    s_mul_i32 s99, s99, 4
    s_add_u32 s99, s99, s97
    s_add_u32 s97, s97, 32
    v_add_u32_dpp v36, v36, v36 quad_perm:[1,0,3,2] row_mask:0xf bank_mask:0xf
    v_add_u32_dpp v37, v37, v37 quad_perm:[1,0,3,2] row_mask:0xf bank_mask:0xf
    s_nop 0
    v_add_u32_dpp v36, v36, v36 quad_perm:[2,3,0,1] row_mask:0xf bank_mask:0xf
    v_add_u32_dpp v37, v37, v37 quad_perm:[2,3,0,1] row_mask:0xf bank_mask:0xf
    s_nop 0
    v_add_u32_dpp v36, v36, v36 row_half_mirror row_mask:0xf bank_mask:0xf
    v_add_u32_dpp v37, v37, v37 row_half_mirror row_mask:0xf bank_mask:0xf
    s_nop 0
    v_add_u32_dpp v36, v36, v36 row_mirror row_mask:0xf bank_mask:0xf
    v_add_u32_dpp v37, v37, v37 row_mirror row_mask:0xf bank_mask:0xf
    v_readlane_b32 s100, v36, 0
    v_readlane_b32 s39, v36, 16
    s_add_u32 s100, s100, s39
    v_readlane_b32 s63, v37, 0
    v_readlane_b32 s39, v37, 16
    s_add_u32 s63, s63, s39
    s_sub_i32 s99, s63, s99
    s_mul_i32 s99, s99, 3
    s_add_i32 s100, s100, s99
    s_add_i32 s100, s100, s58
    s_ashr_i32 s100, s100, 3
    s_add_i32 s100, s100, 8
    s_max_i32 s100, s100, 0
    s_waitcnt lgkmcnt(0)
    v_add_u32 v27, s100, v27
    ds_write_b32 v28, v27 offset:288
    s_branch L_cb
L_cbx:
    s_mov_b64 exec, -1
    s_cmp_eq_u32 s66, -1
    s_cbranch_scc1 L_gl
    v_mov_b32 v26, 0
    s_mov_b32 s72, 131072
    s_nop 0
L_gw:
    ds_read_b32 v27, v26 offset:272
    s_waitcnt lgkmcnt(0)
    v_cmp_gt_u32 vcc, 255, v27
    s_nop 0
    s_cbranch_vccz L_gwd
    s_sleep 1
    s_sub_u32 s72, s72, 1
    s_cbranch_scc0 L_gw
L_gwd:
    buffer_store_dwordx4 v[120:123], v2, s[44:47], s66 offen sc1
    s_nop 1
L_gl:
L_tr3:
    s_setprio 3
    s_barrier
    s_mov_b64 exec, s[56:57]
    ds_read_b128 v[72:75], v6 offset:2048
    ds_read_b128 v[76:79], v6 offset:2176
    s_not_b64 exec, exec
    ds_read_b128 v[80:83], v6 offset:2048
    ds_read_b128 v[84:87], v6 offset:2176
    s_mov_b64 exec, -1
    ds_read_b128 v[88:91], v5 offset:3136
    s_cmp_eq_u32 s67, 0
    s_cbranch_scc1 L_ge
    buffer_load_dwordx4 v[8:11], v20, s[44:47], s64 offen sc1
    buffer_load_dwordx4 v[12:15], v20, s[44:47], s65 offen sc1
L_ge:
    s_waitcnt lgkmcnt(4)
    v_smfmac_f32_16x16x64_bf16 v[92:95], v[72:75], v[128:135], v7
    v_smfmac_f32_16x16x64_bf16 v[96:99], v[72:75], v[192:199], v7
    v_smfmac_f32_16x16x64_bf16 v[100:103], v[72:75], v[144:151], v7
    v_smfmac_f32_16x16x64_bf16 v[104:107], v[72:75], v[208:215], v7
    s_waitcnt lgkmcnt(3)
    v_smfmac_f32_16x16x64_bf16 v[92:95], v[76:79], v[136:143], v7
    v_smfmac_f32_16x16x64_bf16 v[96:99], v[76:79], v[200:207], v7
    v_smfmac_f32_16x16x64_bf16 v[100:103], v[76:79], v[152:159], v7
    v_smfmac_f32_16x16x64_bf16 v[104:107], v[76:79], v[216:223], v7
    s_waitcnt lgkmcnt(2)
    v_smfmac_f32_16x16x64_bf16 v[92:95], v[80:83], v[160:167], v7
    v_smfmac_f32_16x16x64_bf16 v[96:99], v[80:83], v[224:231], v7
    v_smfmac_f32_16x16x64_bf16 v[100:103], v[80:83], v[176:183], v7
    v_smfmac_f32_16x16x64_bf16 v[104:107], v[80:83], v[240:247], v7
    s_waitcnt lgkmcnt(1)
    v_smfmac_f32_16x16x64_bf16 v[92:95], v[84:87], v[168:175], v7
    v_smfmac_f32_16x16x64_bf16 v[96:99], v[84:87], v[232:239], v7
    v_smfmac_f32_16x16x64_bf16 v[100:103], v[84:87], v[184:191], v7
    v_smfmac_f32_16x16x64_bf16 v[104:107], v[84:87], v[248:255], v7
    s_waitcnt lgkmcnt(0)
    s_nop 3
    v_pk_mul_f32 v[92:93], v[92:93], v[88:89]
    v_pk_mul_f32 v[96:97], v[96:97], v[88:89]
    v_pk_mul_f32 v[100:101], v[100:101], v[88:89]
    v_pk_mul_f32 v[104:105], v[104:105], v[88:89]
    v_pk_fma_f32 v[92:93], v[94:95], v[90:91], v[92:93]
    v_pk_fma_f32 v[96:97], v[98:99], v[90:91], v[96:97]
    v_pk_fma_f32 v[100:101], v[102:103], v[90:91], v[100:101]
    v_pk_fma_f32 v[104:105], v[106:107], v[90:91], v[104:105]
    v_add_f32 v44, v92, v93
    v_add_f32 v45, v96, v97
    v_add_f32 v46, v100, v101
    v_add_f32 v47, v104, v105
    v_permlane16_swap_b32 v44, v45
    s_nop 0
    v_permlane16_swap_b32 v46, v47
    v_add_f32 v44, v44, v45
    v_add_f32 v46, v46, v47
    v_add_u32 v68, 0x80, v44
    v_add_u32 v69, 0x80, v46
    v_bfi_b32 v68, v29, s5, v68
    v_bfi_b32 v69, v29, s5, v69
    s_nop 0
    v_permlane32_swap_b32 v68, v70
    v_permlane32_swap_b32 v69, v71
    s_mov_b32 exec_hi, 0
    buffer_store_dwordx4 v[68:71], v2, s[44:47], s59 offen sc1
    s_barrier
    s_cmp_eq_u32 s67, 0
    s_cbranch_scc1 L_gx
    s_mov_b64 exec, -1
    s_mov_b32 s72, 131072
    s_waitcnt vmcnt(1)
L_gp:
    v_xor_b32 v48, s5, v8
    v_xor_b32 v49, s5, v9
    v_xor_b32 v50, s5, v10
    v_xor_b32 v51, s5, v11
    v_xor_b32 v52, s5, v12
    v_xor_b32 v53, s5, v13
    v_xor_b32 v54, s5, v14
    v_xor_b32 v55, s5, v15
    v_or3_b32 v26, v48, v49, v50
    v_or3_b32 v27, v51, v52, v53
    v_or3_b32 v26, v26, v54, v55
    v_bitop3_b32 v26, v26, v27, v29 bitop3:0xa8
    v_cmp_ne_u32 vcc, 0, v26
    s_nop 0
    s_cbranch_vccz L_gd
    s_sleep 4
    buffer_load_dwordx4 v[8:11], v20, s[44:47], s64 offen sc1
    buffer_load_dwordx4 v[12:15], v20, s[44:47], s65 offen sc1
    s_sub_u32 s72, s72, 1
    s_waitcnt vmcnt(0)
    s_cbranch_scc0 L_gp
L_gd:
    v_add_f32_dpp v48, v52, v48 quad_perm:[0,1,2,3] row_mask:0xe bank_mask:0xf
    v_add_f32_dpp v49, v53, v49 quad_perm:[0,1,2,3] row_mask:0xe bank_mask:0xf
    v_add_f32_dpp v50, v54, v50 quad_perm:[0,1,2,3] row_mask:0xe bank_mask:0xf
    v_add_f32_dpp v51, v55, v51 quad_perm:[0,1,2,3] row_mask:0xe bank_mask:0xf
    s_nop 0
    v_permlane32_swap_b32 v48, v50
    v_permlane32_swap_b32 v49, v51
    v_add_f32 v48, v48, v50
    v_add_f32 v49, v49, v51
    s_nop 1
    v_permlane16_swap_b32 v48, v49
    v_add_f32 v48, v48, v49
    s_nop 1
    v_add_f32_dpp v48, v48, v48 row_ror:8 row_mask:0xf bank_mask:0xf
    v_cvt_pk_bf16_f32 v48, v48, v48
    v_and_b32 v48, 0xffff0000, v48
    v_add_f32 v48, v48, v16
    v_cvt_pk_bf16_f32 v48, v48, v48
    v_and_b32 v48, 0xffff0000, v48
    v_mul_f32 v26, 0xbfb8aa3b, v48
    v_exp_f32 v26, v26
    s_nop 0
    v_add_f32 v26, 1.0, v26
    v_rcp_f32 v26, v26
    s_nop 0
    v_mul_f32 v48, v48, v26
    v_cvt_pk_bf16_f32 v48, v48, v48
    v_and_b32 v48, 0xffff0000, v48
    ds_write_b32 v21, v48 offset:3200
    s_waitcnt lgkmcnt(0)
L_gx:
L_end:
    s_endpgm
.section .rodata,"a"
.p2align 6
.amdhsa_kernel recurrent_scan__mha_block_cached__mixer_channel_mlp__decode_kernel
  .amdhsa_next_free_vgpr 256
  .amdhsa_next_free_sgpr 102
  .amdhsa_accum_offset 256
  .amdhsa_group_segment_fixed_size 0
  .amdhsa_kernarg_size 104
  .amdhsa_user_sgpr_count 2
  .amdhsa_user_sgpr_kernarg_segment_ptr 1
  .amdhsa_system_sgpr_workgroup_id_x 1
  .amdhsa_float_denorm_mode_32 3
.end_amdhsa_kernel
```
